```python
import torch

def _softmax(x, axis=-1):
    return torch.softmax(x, dim=axis)
def _gelu(x):
    return torch.nn.functional.gelu(x, approximate="tanh")
def _silu(x):
    return torch.nn.functional.silu(x)
def _sigmoid(x):
    return torch.sigmoid(x)
def _layernorm(x, axis=-1, eps=1e-5):
    m = x.mean(dim=axis, keepdim=True)
    v = x.var(dim=axis, keepdim=True, unbiased=False)
    return (x - m) / torch.sqrt(v + eps)
def _scatter_add(tgt, idx, src, axis=0):
    return tgt.clone().index_add_(axis, idx, src)
def _segment_sum(src, seg, n):
    out = torch.zeros((n,) + src.shape[1:], dtype=src.dtype)
    return out.index_add_(0, seg, src)
def _pad(x, pw):
    flat = tuple(v for pair in reversed(pw) for v in pair)
    return torch.nn.functional.pad(x, flat)

kernel_name = 'standalone__w8a8_smoothquant_per_tensor_per_channel_int8_activations_weights__prompt'

def setup_inputs():

    _w = (lambda a: (lambda t: t.to(torch.bfloat16) if t.is_floating_point() else t)(torch.as_tensor(a)))
    B, S, D, F = 1, 2048, 1024, 3584
    x = abs((lambda *s: torch.randn(*s, dtype=torch.bfloat16) * 0.05)(B, S, D))
    w = (lambda *s: torch.randn(*s, dtype=torch.bfloat16) * 0.05)(D, F)
    x_min, x_max = float(x.min()), float(x.max())
    sx = (x_max - x_min) / 255.0 + 1e-6
    zx = int(torch.as_tensor(-128.0 - x_min / sx).round())
    qx = torch.clamp(torch.as_tensor(x / sx).round() + zx, -128, 127).to(torch.int32)
    sw = (torch.abs(w).amax(dim=0) / 127.0 + 1e-6).to(float)
    qw = torch.clamp(torch.as_tensor(w / sw[None, :]).round(), -127, 127).to(torch.int32)
    return {
        "qx": _w(qx),
        "qw": _w(qw),
        "scale_x": _w(torch.tensor(sx, dtype=float)),
        "zero_x": _w(torch.tensor(zx, dtype=torch.int32)),
        "scale_w": _w(sw),
        "bias": _w((lambda *s: torch.randn(*s, dtype=torch.bfloat16) * 0.05)(F)),
    }

def reference(qx, qw, scale_x, zero_x, scale_w, bias):
    dt = scale_w.dtype
    acc = torch.einsum("bsd,df->bsf", (lambda x, dt: x.to(dt))(qx, dt), (lambda x, dt: x.to(dt))(qw, dt))
    w_colsum = torch.sum((lambda x, dt: x.to(dt))(qw, dt), axis=0)
    acc = acc - (lambda x, dt: x.to(dt))(zero_x, dt) * w_colsum[None, None, :]
    return acc * scale_x * scale_w[None, None, :] + bias[None, None, :]
```

```asm
; @launch grid=(256,1,1) block=(256,1,1) lds=133120
.amdgcn_target "amdgcn-amd-amdhsa--gfx950"
.text
.globl standalone__w8a8_smoothquant_per_tensor_per_channel_int8_activations_weights__prompt_kernel
.p2align 8
.type standalone__w8a8_smoothquant_per_tensor_per_channel_int8_activations_weights__prompt_kernel,@function
standalone__w8a8_smoothquant_per_tensor_per_channel_int8_activations_weights__prompt_kernel:
    s_load_dwordx4 s[4:7], s[0:1], 0
    s_load_dwordx4 s[56:59], s[0:1], 56
    s_memrealtime s[32:33]
    s_cmp_ge_u32 s2, 256
    s_cbranch_scc1 K_END
    s_getpc_b64 s[66:67]
CPF_0:
    v_lshlrev_b32 v243, 4, v0
    v_min_u32 v243, 2560, v243
    global_load_dword v243, v243, s[66:67] offset:128
    v_lshrrev_b32 v1, 6, v0
    v_and_b32 v2, 63, v0
    v_readfirstlane_b32 s3, v1
    s_mov_b32 s14, 14680064
    s_mov_b32 s11, 0x00020000
    s_and_b32 s40, s2, 1
    s_lshl_b32 s40, s40, 3
    s_bfe_u32 s41, s2, 0x30003
    s_add_u32 s40, s40, s41
    s_bfe_u32 s41, s2, 0x20001
    s_lshl_b32 s41, s41, 2
    s_lshr_b32 s42, s2, 6
    s_add_u32 s41, s41, s42
    s_lshl_b32 s44, s40, 4
    s_add_u32 s44, s44, s41
    v_lshrrev_b32 v4, 3, v2
    v_and_b32 v7, 7, v2
    v_lshrrev_b32 v8, 4, v2
    v_mul_u32_u24 v6, 1835008, v8
    v_lshlrev_b32 v5, 12, v4
    v_lshl_add_u32 v5, v7, 4, v5
    v_and_b32 v9, 15, v2
    v_lshl_add_u32 v9, v9, 4, v6
    v_cmp_gt_u32 vcc, 128, v0
    s_lshr_b32 s45, s40, 3
    s_lshl_b32 s45, s45, 7
    s_and_b32 s46, s40, 7
    s_add_u32 s45, s45, s46
    s_mul_i32 s45, s45, 57344
    s_mul_i32 s46, s41, 896
    s_add_u32 s46, s46, 128
    s_and_b32 s46, s46, 0xffffff00
    s_add_u32 s45, s45, s46
    s_and_b32 s47, s3, 1
    s_lshl_b32 s46, s47, 8
    s_add_u32 s45, s45, s46
    s_lshl_b32 s46, s44, 15
    s_lshl_b32 s47, s47, 11
    s_add_u32 s46, s46, s47
    v_cndmask_b32 v5, v9, v5, vcc
    s_mov_b32 s64, 14336
    s_mov_b32 s65, 458752
    s_cmp_lt_u32 s3, 2
    s_cselect_b32 s45, s46, s45
    s_cselect_b32 s64, 512, s64
    s_cselect_b32 s65, 128, s65
    s_cselect_b32 s10, 8388608, s14
    s_waitcnt lgkmcnt(0)
    s_cselect_b64 s[8:9], s[4:5], s[6:7]
    s_mov_b32 s51, s45
    buffer_load_dwordx4 v[16:19], v5, s[8:11], s51 offen nt
    s_add_u32 s51, s51, s64
    buffer_load_dwordx4 v[20:23], v5, s[8:11], s51 offen nt
    s_add_u32 s51, s51, s64
    buffer_load_dwordx4 v[24:27], v5, s[8:11], s51 offen nt
    s_add_u32 s51, s51, s64
    buffer_load_dwordx4 v[28:31], v5, s[8:11], s51 offen nt
    s_add_u32 s45, s45, s65
    s_mov_b32 s51, s45
    buffer_load_dwordx4 v[32:35], v5, s[8:11], s51 offen nt
    s_lshr_b32 s46, s2, 3
    s_or_b32 s46, s46, s3
    s_cbranch_scc1 NOPUB
    s_or_b32 s32, s32, 1
    v_mov_b32 v12, s32
    v_mov_b32 v13, 0
    s_mov_b64 exec, 1
    global_atomic_cmpswap v13, v[12:13], s[56:57] sc1
    s_mov_b64 exec, -1
NOPUB:
    s_cmp_eq_u32 s3, 0
    s_cselect_b64 s[12:13], s[4:5], s[6:7]
    s_cselect_b32 s14, 8388608, s14
    s_mov_b64 s[16:17], s[58:59]
    s_load_dwordx4 s[4:7], s[0:1], 16
    s_load_dwordx2 s[20:21], s[0:1], 32
    s_load_dwordx2 s[24:25], s[0:1], 40
    s_load_dwordx2 s[28:29], s[0:1], 48
    v_lshlrev_b32 v3, 4, v2
    s_getpc_b64 s[66:67]
CPF_P:
    s_add_u32 s66, s66, PAGE0-CPF_P
    s_addc_u32 s67, s67, 0
    s_bfe_u32 s55, s2, 0x30003
    s_lshl_b32 s55, s55, 2
    s_add_u32 s55, s55, s3
    s_lshl_b32 s55, s55, 9
    v_and_b32 v237, 0x1f0, v3
    v_add_u32 v237, s55, v237
    v_min_u32 v237, K_END-PAGE0+1024, v237
    global_load_dword v237, v237, s[66:67]
    s_mov_b32 s18, 8388608
    s_mov_b32 s19, 0x00020000
    s_bfe_u32 s33, s40, 0x20001
    s_lshl_b32 s33, s33, 2
    s_lshr_b32 s53, s40, 3
    s_lshl_b32 s53, s53, 1
    s_add_u32 s33, s33, s53
    s_and_b32 s53, s40, 1
    s_add_u32 s33, s33, s53
    s_add_u32 s55, s41, 16
    s_cmp_lt_u32 s3, 2
    s_cselect_b32 s52, s40, s55
    s_cselect_b32 s53, s41, s33
    s_mul_i32 s52, s52, 4352
    s_lshl_b32 s53, s53, 1
    s_and_b32 s33, s3, 1
    s_add_u32 s53, s53, s33
    s_lshl_b32 s53, s53, 2
    s_add_u32 s52, s52, s53
    s_add_u32 s52, s52, 7340032
    s_mul_i32 s55, s55, 4352
    s_lshl_b32 s53, s40, 2
    s_add_u32 s55, s55, s53
    s_mul_i32 s33, s40, 4352
    s_lshl_b32 s53, s41, 2
    s_add_u32 s33, s33, s53
    v_mov_b32 v241, s55
    v_mov_b32 v232, 0
    v_writelane_b32 v241, s33, 0
    v_cmp_gt_u32 vcc, 2, v2
    v_min_u32 v14, 5, v2
    v_mul_u32_u24 v14, 139264, v14
    s_sub_u32 s53, s52, 278528
    v_add_u32 v14, s53, v14
    v_add_u32 v15, 7897088, v241
    v_cndmask_b32 v14, v14, v15, vcc
    buffer_load_dword v236, v14, s[16:19], 0 offen sc1
    s_mul_i32 s60, s41, 233472
    s_add_u32 s60, s60, 2097152
    v_and_b32 v11, 1, v8
    v_lshrrev_b32 v10, 1, v8
    s_cmp_lt_u32 s3, 2
    s_cbranch_scc0 IFW0
    v_lshlrev_b32 v9, 8, v7
    v_lshl_add_u32 v9, v4, 4, v9
    s_lshr_b32 s61, s44, 1
    s_lshl_b32 s61, s61, 14
    s_and_b32 s49, s41, 1
    s_lshl_b32 s49, s49, 7
    s_add_u32 s61, s61, s49
    s_lshl_b32 s49, s3, 11
    s_add_u32 s61, s61, s49
    s_lshr_b32 s49, s41, 2
    s_lshl_b32 s49, s49, 12
    s_xor_b32 s61, s61, s49
    s_xor_b32 s49, s61, 4096
    s_xor_b32 s50, s61, 8192
    s_branch IFE0
IFW0:
    v_and_b32 v9, 15, v2
    v_lshlrev_b32 v9, 4, v9
    v_lshl_add_u32 v9, v10, 8, v9
    v_lshl_add_u32 v9, v11, 15, v9
    s_sub_u32 s61, s3, 2
    s_lshl_b32 s61, s61, 16
    s_add_u32 s61, s61, s60
    s_lshl_b32 s49, s40, 9
    s_add_u32 s61, s61, s49
    s_add_u32 s49, s61, 8192
    s_add_u32 s50, s61, 16384
IFE0:
    v_add_u32 v116, s61, v9
    v_add_u32 v117, s49, v9
    v_add_u32 v118, s50, v9
    s_mov_b32 s54, 0x01010101
    s_waitcnt vmcnt(6)
    s_add_u32 s51, s51, s64
    buffer_load_dwordx4 v[36:39], v5, s[8:11], s51 offen nt
    s_waitcnt vmcnt(6)
    s_add_u32 s51, s51, s64
    buffer_load_dwordx4 v[40:43], v5, s[8:11], s51 offen nt
    s_waitcnt vmcnt(6)
    s_add_u32 s51, s51, s64
    buffer_load_dwordx4 v[44:47], v5, s[8:11], s51 offen nt
    s_waitcnt vmcnt(6)
    s_add_u32 s45, s45, s65
    s_mov_b32 s51, s45
    buffer_load_dwordx4 v[48:51], v5, s[8:11], s51 offen nt
    s_cmp_lt_u32 s3, 2
    s_cbranch_scc0 IFW1
    v_ashr_pk_i8_i32 v200, v16, v17, 0
    v_ashr_pk_i8_i32 v201, v20, v21, 0
    v_ashr_pk_i8_i32 v202, v24, v25, 0
    v_ashr_pk_i8_i32 v203, v28, v29, 0
    v_ashr_pk_i8_i32 v200, v18, v19, 0 op_sel:[0,0,0,1]
    v_ashr_pk_i8_i32 v201, v22, v23, 0 op_sel:[0,0,0,1]
    v_ashr_pk_i8_i32 v202, v26, v27, 0 op_sel:[0,0,0,1]
    v_ashr_pk_i8_i32 v203, v30, v31, 0 op_sel:[0,0,0,1]
    buffer_store_dwordx4 v[200:203], v116, s[16:19], 0 offen sc1
    s_branch IFE1
IFW1:
    v_ashr_pk_i8_i32 v200, v16, v20, 0
    v_ashr_pk_i8_i32 v201, v18, v22, 0
    v_ashr_pk_i8_i32 v202, v17, v21, 0
    v_ashr_pk_i8_i32 v203, v19, v23, 0
    v_ashr_pk_i8_i32 v200, v24, v28, 0 op_sel:[0,0,0,1]
    v_ashr_pk_i8_i32 v201, v26, v30, 0 op_sel:[0,0,0,1]
    v_ashr_pk_i8_i32 v202, v25, v29, 0 op_sel:[0,0,0,1]
    v_ashr_pk_i8_i32 v203, v27, v31, 0 op_sel:[0,0,0,1]
    s_nop 1
    v_permlane32_swap_b32 v200, v202
    v_permlane32_swap_b32 v201, v203
    s_nop 1
    v_permlane16_swap_b32 v200, v201
    v_permlane16_swap_b32 v202, v203
    buffer_store_dwordx4 v[200:203], v116, s[16:19], 0 offen sc1
    v_dot4_i32_i8 v1, v200, s54, 0
    v_dot4_i32_i8 v1, v201, s54, v1
    v_dot4_i32_i8 v1, v202, s54, v1
    v_dot4_i32_i8 v1, v203, s54, v1
IFE1:
    s_waitcnt vmcnt(7)
    global_load_dword v235, v232, s[56:57] sc1
    s_add_u32 s51, s51, s64
    buffer_load_dwordx4 v[52:55], v5, s[8:11], s51 offen nt
    s_mov_b32 s15, 0x00020000
    s_sub_u32 s42, s3, 1
    s_and_b32 s42, s42, 3
    s_lshl_b32 s62, s42, 7
    s_cmp_lt_u32 s42, 2
    s_cselect_b32 s63, s62, 65536
    s_add_u32 s42, s62, 512
    s_add_u32 s63, s63, s60
    s_lshl_b32 s62, s40, 10
    s_add_u32 s63, s63, s62
    s_add_u32 s63, s63, 131072
    s_bfe_u32 s62, s40, 0x10002
    s_lshl_b32 s62, s62, 6
    s_lshr_b32 s50, s40, 3
    s_lshl_b32 s50, s50, 2
    s_add_u32 s62, s62, s50
    s_and_b32 s50, s40, 3
    s_add_u32 s62, s62, s50
    s_mul_i32 s62, s62, 114688
    s_mul_i32 s50, s41, 896
    s_add_u32 s62, s62, s50
    s_and_b32 s50, s41, 1
    s_lshl_b32 s50, s50, 7
    s_add_u32 s50, s50, s42
    s_cmp_ge_u32 s50, 896
    s_cselect_b32 s50, 0, s50
    s_add_u32 s62, s62, s50
    v_and_b32 v114, 1, v4
    v_mul_u32_u24 v115, 57344, v114
    v_add_u32 v6, v6, v115
    v_lshl_add_u32 v6, v7, 4, v6
    v_lshl_add_u32 v112, v11, 1, v10
    v_lshlrev_b32 v10, 8, v10
    v_lshl_add_u32 v10, v114, 9, v10
    v_lshl_add_u32 v115, v7, 5, v10
    v_lshl_add_u32 v115, v11, 4, v115
    v_lshl_add_u32 v10, v7, 4, v10
    v_cmp_gt_u32 vcc, 192, v0
    v_lshl_add_u32 v10, v11, 15, v10
    s_add_u32 s46, s45, s65
    s_mov_b32 s34, 14336
    v_cndmask_b32 v10, v115, v10, vcc
    s_add_u32 s48, s62, 917504
    s_add_u32 s49, s63, 16384
    s_cmp_lt_u32 s3, 1
    s_cbranch_scc0 IFW2
    s_add_u32 s47, s46, 1536
    s_add_u32 s48, s46, 2560
    s_add_u32 s46, s46, 0
    v_mov_b32 v12, v5
    v_mov_b32 v13, v5
    s_xor_b32 s50, s61, 0x3000
    v_add_u32 v119, s50, v9
    v_mov_b32 v224, 1073741824
    v_add_u32 v225, 2048, v119
    s_branch IFE2
IFW2:
    v_mov_b32 v12, v6
    s_cmp_lt_u32 s3, 2
    s_cbranch_scc0 IFW3
    s_mov_b32 s46, s62
    s_mov_b32 s47, s48
    s_mov_b32 s48, 1073741824
    v_mov_b32 v13, v6
    v_add_u32 v119, s63, v10
    v_add_u32 v224, s49, v10
    v_mov_b32 v225, 1073741824
    s_branch IFE3
IFW3:
    s_mov_b32 s47, s62
    v_mov_b32 v13, v5
    v_add_u32 v119, 8192, v118
    v_add_u32 v224, s63, v10
    v_add_u32 v225, s49, v10
IFE3:
IFE2:
    v_and_b32 v113, 15, v2
    v_lshl_add_u32 v113, v113, 2, v112
    v_lshlrev_b32 v8, 1, v113
    v_and_b32 v11, 0x3f, v8
    s_lshl_b32 s50, s41, 4
    s_add_u32 s50, s50, s40
    s_lshl_b32 s50, s50, 9
    s_add_u32 s50, s50, 6291456
    s_lshr_b32 s42, s42, 1
    s_and_b32 s49, s3, 1
    s_lshl_b32 s49, s49, 7
    s_add_u32 s49, s49, s50
    s_cmp_lt_u32 s3, 2
    s_cselect_b32 s49, 1073741824, s49
    s_add_u32 s50, s50, s42
    s_add_u32 s36, s16, s60
    s_addc_u32 s37, s17, 0
    s_mov_b32 s38, 229376
    s_mov_b32 s39, 0x00020000
    s_lshl_b32 s55, s3, 6
    v_add_u32 v240, s55, v113
    s_waitcnt lgkmcnt(0)
    s_mov_b32 s22, 7168
    s_mov_b32 s23, 0x00020000
    s_mov_b32 s26, 7168
    s_mov_b32 s27, 0x00020000
    s_and_b32 s55, s41, 1
    s_lshl_b32 s55, s55, 5
    v_add_u32 v114, s55, v240
    v_subrev_u32 v115, 224, v114
    v_min_u32 v114, v114, v115
    s_mul_i32 s55, s41, 448
    v_lshl_add_u32 v114, v114, 1, s55
    buffer_load_ushort v238, v114, s[20:23], 0 offen
    buffer_load_ushort v239, v114, s[24:27], 0 offen
    s_load_dword s44, s[4:5], 0
    s_load_dword s65, s[6:7], 0
    s_mul_i32 s53, s41, 4352
    s_add_u32 s53, s53, 69504
    s_mul_i32 s55, s40, 4352
    v_cmp_gt_u32 vcc, 32, v2
    v_mov_b32 v114, s53
    v_mov_b32 v112, s55
    v_cndmask_b32 v114, v114, v112, vcc
    v_lshl_add_u32 v233, v2, 2, v114
    v_and_b32 v115, 0x2f, v2
    v_lshl_add_u32 v234, v115, 2, v114
    s_mov_b32 s53, 7479296
    s_waitcnt vmcnt(8)
    s_add_u32 s51, s51, s64
    buffer_load_dwordx4 v[56:59], v5, s[8:11], s51 offen nt
    s_waitcnt vmcnt(8)
    s_add_u32 s51, s51, s64
    buffer_load_dwordx4 v[60:63], v5, s[8:11], s51 offen nt
    s_waitcnt vmcnt(8)
    s_mov_b32 s51, s46
    buffer_load_dwordx4 v[64:67], v13, s[12:15], s51 offen nt
    s_cmp_lt_u32 s3, 2
    s_cbranch_scc0 IFW4
    v_ashr_pk_i8_i32 v204, v32, v33, 0
    v_ashr_pk_i8_i32 v205, v36, v37, 0
    v_ashr_pk_i8_i32 v206, v40, v41, 0
    v_ashr_pk_i8_i32 v207, v44, v45, 0
    v_ashr_pk_i8_i32 v204, v34, v35, 0 op_sel:[0,0,0,1]
    v_ashr_pk_i8_i32 v205, v38, v39, 0 op_sel:[0,0,0,1]
    v_ashr_pk_i8_i32 v206, v42, v43, 0 op_sel:[0,0,0,1]
    v_ashr_pk_i8_i32 v207, v46, v47, 0 op_sel:[0,0,0,1]
    buffer_store_dwordx4 v[204:207], v117, s[16:19], 0 offen sc1
    s_branch IFE4
IFW4:
    v_ashr_pk_i8_i32 v204, v32, v36, 0
    v_ashr_pk_i8_i32 v205, v34, v38, 0
    v_ashr_pk_i8_i32 v206, v33, v37, 0
    v_ashr_pk_i8_i32 v207, v35, v39, 0
    v_ashr_pk_i8_i32 v204, v40, v44, 0 op_sel:[0,0,0,1]
    v_ashr_pk_i8_i32 v205, v42, v46, 0 op_sel:[0,0,0,1]
    v_ashr_pk_i8_i32 v206, v41, v45, 0 op_sel:[0,0,0,1]
    v_ashr_pk_i8_i32 v207, v43, v47, 0 op_sel:[0,0,0,1]
    s_nop 1
    v_permlane32_swap_b32 v204, v206
    v_permlane32_swap_b32 v205, v207
    s_nop 1
    v_permlane16_swap_b32 v204, v205
    v_permlane16_swap_b32 v206, v207
    buffer_store_dwordx4 v[204:207], v117, s[16:19], 0 offen sc1
    v_dot4_i32_i8 v1, v204, s54, v1
    v_dot4_i32_i8 v1, v205, s54, v1
    v_dot4_i32_i8 v1, v206, s54, v1
    v_dot4_i32_i8 v1, v207, s54, v1
IFE4:
    s_waitcnt vmcnt(9)
    s_cmp_eq_u32 s3, 0
    s_cselect_b32 s35, 512, s34
    s_add_u32 s51, s51, s35
    buffer_load_dwordx4 v[68:71], v13, s[12:15], s51 offen nt
    s_waitcnt vmcnt(7)
    v_readfirstlane_b32 s43, v235
    s_mov_b32 s55, 200000
    s_cmp_lg_u32 s43, 0
    s_cbranch_scc1 TAG_OK
TAG_RETRY:
    global_load_dword v235, v232, s[56:57] sc1
    s_sub_u32 s55, s55, 1
    s_waitcnt vmcnt(0)
    v_readfirstlane_b32 s43, v235
    s_cmp_eq_u32 s55, 0
    s_cbranch_scc1 TAG_OK
    s_cmp_eq_u32 s43, 0
    s_cbranch_scc1 TAG_RETRY
TAG_OK:
    s_mov_b64 exec, 1
    buffer_store_dword v235, v232, s[16:19], s52 offen sc1
    s_mov_b64 exec, -1
    s_add_u32 s52, s52, 139264
    s_cmp_eq_u32 s3, 0
    s_cselect_b32 s35, 512, s34
    s_add_u32 s51, s51, s35
    buffer_load_dwordx4 v[72:75], v13, s[12:15], s51 offen nt
    s_mov_b32 s30, 14680064
    s_mov_b32 s31, 0x00020000
    s_lshl_b32 s42, s40, 2
    s_add_u32 s42, s42, s3
    s_lshl_b32 s62, s42, 15
    s_lshl_b32 s61, s3, 12
    s_add_u32 s62, s62, s61
    s_add_u32 s63, s62, 16384
    s_lshl_b32 s60, s3, 10
    v_lshrrev_b32 v112, 4, v2
    v_and_b32 v113, 15, v2
    v_lshlrev_b32 v244, 9, v112
    v_lshl_add_u32 v244, v113, 4, v244
    v_add_u32 v245, 65536, v244
    v_mul_u32_u24 v246, 28672, v112
    v_lshl_add_u32 v247, v113, 2, v246
    v_lshl_add_u32 v246, v113, 3, v246
    s_and_b32 s55, s41, 1
    s_cselect_b32 s55, 64, 0
    v_add_u32 v246, s55, v246
    s_cselect_b32 s55, 0, 384
    v_add_u32 v247, s55, v247
    s_mov_b32 s55, 131072
    v_lshl_add_u32 v248, v113, 2, s55
    v_lshrrev_b32 v114, 1, v113
    v_lshl_add_u32 v249, v114, 2, s55
    v_and_b32 v114, 1, v113
    v_lshl_add_u32 v249, v114, 6, v249
    v_lshl_add_u32 v250, v0, 2, s55
    v_lshlrev_b32 v251, 11, v112
    v_lshl_add_u32 v251, v113, 3, v251
    s_lshl_b32 s32, s41, 13
    s_lshl_b32 s55, s3, 7
    s_add_u32 s32, s32, s55
    s_add_u32 s32, s32, 6291456
    s_mul_i32 s68, s42, 229376
    s_mul_i32 s55, s41, 448
    s_add_u32 s68, s68, s55
    s_add_u32 s69, s68, 7168
    s_add_u32 s70, s68, 14336
    s_add_u32 s71, s68, 21504
    s_add_u32 s72, s68, 114688
    s_add_u32 s73, s68, 121856
    s_add_u32 s74, s68, 129024
    s_add_u32 s75, s68, 136192
    s_mul_i32 s56, s40, 4352
    s_mul_i32 s58, s41, 4352
    s_lshl_b32 s55, s3, 5
    s_add_u32 s55, s55, 7340032
    s_add_u32 s56, s56, s55
    s_add_u32 s58, s58, s55
    s_add_u32 s58, s58, 69632
    s_add_u32 s56, s56, s16
    s_addc_u32 s57, s17, 0
    s_add_u32 s58, s58, s16
    s_addc_u32 s59, s17, 0
    s_branch PAGE0
.p2align 12
PAGE0:
    s_waitcnt vmcnt(6)
    s_cmp_eq_u32 s3, 0
    s_cselect_b32 s35, 1073740800, s34
    s_add_u32 s51, s51, s35
    buffer_load_dwordx4 v[76:79], v13, s[12:15], s51 offen nt
    s_waitcnt vmcnt(6)
    s_mov_b32 s51, s47
    buffer_load_dwordx4 v[80:83], v12, s[12:15], s51 offen nt
    s_cmp_lt_u32 s3, 2
    s_cbranch_scc0 IFW5
    v_ashr_pk_i8_i32 v208, v48, v49, 0
    v_ashr_pk_i8_i32 v209, v52, v53, 0
    v_ashr_pk_i8_i32 v210, v56, v57, 0
    v_ashr_pk_i8_i32 v211, v60, v61, 0
    v_ashr_pk_i8_i32 v208, v50, v51, 0 op_sel:[0,0,0,1]
    v_ashr_pk_i8_i32 v209, v54, v55, 0 op_sel:[0,0,0,1]
    v_ashr_pk_i8_i32 v210, v58, v59, 0 op_sel:[0,0,0,1]
    v_ashr_pk_i8_i32 v211, v62, v63, 0 op_sel:[0,0,0,1]
    buffer_store_dwordx4 v[208:211], v118, s[16:19], 0 offen sc1
    s_branch IFE5
IFW5:
    v_ashr_pk_i8_i32 v208, v48, v52, 0
    v_ashr_pk_i8_i32 v209, v50, v54, 0
    v_ashr_pk_i8_i32 v210, v49, v53, 0
    v_ashr_pk_i8_i32 v211, v51, v55, 0
    v_ashr_pk_i8_i32 v208, v56, v60, 0 op_sel:[0,0,0,1]
    v_ashr_pk_i8_i32 v209, v58, v62, 0 op_sel:[0,0,0,1]
    v_ashr_pk_i8_i32 v210, v57, v61, 0 op_sel:[0,0,0,1]
    v_ashr_pk_i8_i32 v211, v59, v63, 0 op_sel:[0,0,0,1]
    s_nop 1
    v_permlane32_swap_b32 v208, v210
    v_permlane32_swap_b32 v209, v211
    s_nop 1
    v_permlane16_swap_b32 v208, v209
    v_permlane16_swap_b32 v210, v211
    buffer_store_dwordx4 v[208:211], v118, s[16:19], 0 offen sc1
    v_dot4_i32_i8 v1, v208, s54, v1
    v_dot4_i32_i8 v1, v209, s54, v1
    v_dot4_i32_i8 v1, v210, s54, v1
    v_dot4_i32_i8 v1, v211, s54, v1
IFE5:
    s_waitcnt vmcnt(7)
    s_cmp_eq_u32 s3, 0
    s_cselect_b32 s35, 1073740288, s34
    s_add_u32 s51, s51, s35
    buffer_load_dwordx4 v[84:87], v12, s[12:15], s51 offen nt
    s_cmp_eq_u32 s3, 0
    s_cselect_b32 s35, 3221227520, s34
    s_add_u32 s51, s51, s35
    buffer_load_dwordx4 v[88:91], v12, s[12:15], s51 offen nt
    s_waitcnt vmcnt(7)
    s_mov_b64 exec, 1
    buffer_store_dword v235, v232, s[16:19], s52 offen sc1
    s_mov_b64 exec, -1
    s_add_u32 s52, s52, 139264
    s_cmp_eq_u32 s3, 0
    s_cselect_b32 s35, 1073739776, s34
    s_add_u32 s51, s51, s35
    buffer_load_dwordx4 v[92:95], v12, s[12:15], s51 offen nt
    s_waitcnt vmcnt(7)
    s_mov_b32 s51, s48
    buffer_load_dwordx4 v[96:99], v12, s[12:15], s51 offen nt
    s_waitcnt lgkmcnt(0)
    s_lshl_b32 s44, s44, 16
    v_cvt_f32_i32 v252, s65
    v_lshlrev_b32 v238, 16, v238
    v_lshlrev_b32 v239, 16, v239
    v_mul_f32 v238, s44, v238
    v_cvt_pk_bf16_f32 v252, v252, v252
    v_lshlrev_b32 v252, 16, v252
    ds_write_b32 v250, v238
    s_waitcnt lgkmcnt(0)
    s_mov_b64 vcc, -1
    s_branch ISL1
WARMRET:
    s_waitcnt vmcnt(7)
    s_cmp_eq_u32 s3, 0
    s_cselect_b32 s35, 1073739264, s34
    s_add_u32 s51, s51, s35
    buffer_load_dwordx4 v[100:103], v12, s[12:15], s51 offen nt
    s_cmp_lt_u32 s3, 1
    s_cbranch_scc0 IFW6
    s_branch IFE6
IFW6:
    v_ashr_pk_i8_i32 v212, v64, v68, 0
    v_ashr_pk_i8_i32 v213, v66, v70, 0
    v_ashr_pk_i8_i32 v214, v65, v69, 0
    v_ashr_pk_i8_i32 v215, v67, v71, 0
    v_ashr_pk_i8_i32 v212, v72, v76, 0 op_sel:[0,0,0,1]
    v_ashr_pk_i8_i32 v213, v74, v78, 0 op_sel:[0,0,0,1]
    v_ashr_pk_i8_i32 v214, v73, v77, 0 op_sel:[0,0,0,1]
    v_ashr_pk_i8_i32 v215, v75, v79, 0 op_sel:[0,0,0,1]
    s_nop 1
    v_permlane32_swap_b32 v212, v214
    v_permlane32_swap_b32 v213, v215
    s_nop 1
    v_permlane16_swap_b32 v212, v213
    v_permlane16_swap_b32 v214, v215
    v_dot4_i32_i8 v226, v212, s54, 0
    v_dot4_i32_i8 v226, v213, s54, v226
    v_dot4_i32_i8 v226, v214, s54, v226
    v_dot4_i32_i8 v226, v215, s54, v226
IFE6:
    s_nop 2
    v_add_u32 v1, v1, v226
    buffer_store_short v1, v8, s[16:19], s49 offen sc1
    s_waitcnt vmcnt(8)
    s_cmp_eq_u32 s3, 0
    s_cselect_b32 s35, 3221228544, s34
    s_add_u32 s51, s51, s35
    buffer_load_dwordx4 v[104:107], v12, s[12:15], s51 offen nt
    s_cmp_lt_u32 s3, 1
    s_cbranch_scc0 IFW7
    v_ashr_pk_i8_i32 v212, v64, v65, 0
    v_ashr_pk_i8_i32 v213, v68, v69, 0
    v_ashr_pk_i8_i32 v214, v72, v73, 0
    v_ashr_pk_i8_i32 v215, v80, v81, 0
    v_ashr_pk_i8_i32 v212, v66, v67, 0 op_sel:[0,0,0,1]
    v_ashr_pk_i8_i32 v213, v70, v71, 0 op_sel:[0,0,0,1]
    v_ashr_pk_i8_i32 v214, v74, v75, 0 op_sel:[0,0,0,1]
    v_ashr_pk_i8_i32 v215, v82, v83, 0 op_sel:[0,0,0,1]
    s_branch IFE7
IFW7:
IFE7:
    buffer_store_dwordx4 v[212:215], v119, s[16:19], 0 offen sc1
    s_load_dwordx8 s[4:11], s[56:57], 0
    s_load_dwordx8 s[20:27], s[58:59], 0
    s_waitcnt vmcnt(8)
    s_mov_b64 exec, 1
    buffer_store_dword v235, v232, s[16:19], s52 offen sc1
    s_mov_b64 exec, -1
    s_add_u32 s52, s52, 139264
    s_cmp_eq_u32 s3, 0
    s_cselect_b32 s35, 512, s34
    s_add_u32 s51, s51, s35
    buffer_load_dwordx4 v[108:111], v12, s[12:15], s51 offen nt
    s_waitcnt vmcnt(9)
    s_waitcnt vmcnt(7)
    s_cmp_lt_u32 s3, 1
    s_cbranch_scc0 IFW8
    s_branch IFE8
IFW8:
    v_ashr_pk_i8_i32 v216, v80, v84, 0
    v_ashr_pk_i8_i32 v217, v82, v86, 0
    v_ashr_pk_i8_i32 v218, v81, v85, 0
    v_ashr_pk_i8_i32 v219, v83, v87, 0
    v_ashr_pk_i8_i32 v216, v88, v92, 0 op_sel:[0,0,0,1]
    v_ashr_pk_i8_i32 v217, v90, v94, 0 op_sel:[0,0,0,1]
    v_ashr_pk_i8_i32 v218, v89, v93, 0 op_sel:[0,0,0,1]
    v_ashr_pk_i8_i32 v219, v91, v95, 0 op_sel:[0,0,0,1]
    s_nop 1
    v_permlane32_swap_b32 v216, v218
    v_permlane32_swap_b32 v217, v219
    s_nop 1
    v_permlane16_swap_b32 v216, v217
    v_permlane16_swap_b32 v218, v219
    v_dot4_i32_i8 v227, v216, s54, 0
    v_dot4_i32_i8 v227, v217, s54, v227
    v_dot4_i32_i8 v227, v218, s54, v227
    v_dot4_i32_i8 v227, v219, s54, v227
IFE8:
    s_waitcnt vmcnt(6)
    s_mov_b32 s42, s43
    s_mov_b64 vcc, 0
    s_waitcnt lgkmcnt(0)
    s_xor_b64 s[4:5], s[4:5], s[42:43]
    s_xor_b64 s[6:7], s[6:7], s[42:43]
    s_xor_b64 s[8:9], s[8:9], s[42:43]
    s_xor_b64 s[10:11], s[10:11], s[42:43]
    s_xor_b64 s[20:21], s[20:21], s[42:43]
    s_xor_b64 s[22:23], s[22:23], s[42:43]
    s_xor_b64 s[24:25], s[24:25], s[42:43]
    s_xor_b64 s[26:27], s[26:27], s[42:43]
    s_or_b64 s[4:5], s[4:5], s[6:7]
    s_or_b64 s[8:9], s[8:9], s[10:11]
    s_or_b64 s[20:21], s[20:21], s[22:23]
    s_or_b64 s[24:25], s[24:25], s[26:27]
    s_or_b64 s[4:5], s[4:5], s[8:9]
    s_or_b64 s[20:21], s[20:21], s[24:25]
    s_or_b64 s[4:5], s[4:5], s[20:21]
    s_cbranch_scc1 PO0_SLOW
PO0_OK:
    s_add_u32 m0, s60, 0
    s_nop 0
    buffer_load_dwordx4 v3, s[36:39], m0 offen sc1 lds
    s_add_u32 m0, s60, 32768
    s_nop 0
    buffer_load_dwordx4 v3, s[36:39], m0 offen sc1 lds
    s_add_u32 m0, s60, 65536
    s_nop 0
    buffer_load_dwordx4 v3, s[36:39], m0 offen sc1 lds
    s_add_u32 m0, s60, 98304
    s_nop 0
    buffer_load_dwordx4 v3, s[36:39], m0 offen sc1 lds
    buffer_load_dwordx4 a[0:3], v3, s[16:19], s62 offen offset:0 sc1
    buffer_load_dwordx4 a[64:67], v3, s[16:19], s63 offen offset:0 sc1
    s_waitcnt vmcnt(11)
    s_load_dwordx8 s[4:11], s[56:57], 139264
    s_load_dwordx8 s[20:27], s[58:59], 139264
    buffer_load_dwordx4 a[4:7], v3, s[16:19], s62 offen offset:1024 sc1
    s_waitcnt vmcnt(10)
    buffer_load_dwordx4 a[68:71], v3, s[16:19], s63 offen offset:1024 sc1
    s_waitcnt vmcnt(8)
    s_add_u32 m0, s60, 4096
    s_nop 0
    buffer_load_dwordx4 v3, s[36:39], m0 offen sc1 lds
    s_cmp_lt_u32 s3, 1
    s_cbranch_scc0 IFW9
    v_ashr_pk_i8_i32 v220, v88, v89, 0
    v_ashr_pk_i8_i32 v221, v96, v97, 0
    v_ashr_pk_i8_i32 v222, v104, v105, 0
    v_ashr_pk_i8_i32 v223, v108, v109, 0
    v_ashr_pk_i8_i32 v220, v90, v91, 0 op_sel:[0,0,0,1]
    v_ashr_pk_i8_i32 v221, v98, v99, 0 op_sel:[0,0,0,1]
    v_ashr_pk_i8_i32 v222, v106, v107, 0 op_sel:[0,0,0,1]
    v_ashr_pk_i8_i32 v223, v110, v111, 0 op_sel:[0,0,0,1]
    s_branch IFE9
IFW9:
    v_ashr_pk_i8_i32 v220, v96, v100, 0
    v_ashr_pk_i8_i32 v221, v98, v102, 0
    v_ashr_pk_i8_i32 v222, v97, v101, 0
    v_ashr_pk_i8_i32 v223, v99, v103, 0
    v_ashr_pk_i8_i32 v220, v104, v108, 0 op_sel:[0,0,0,1]
    v_ashr_pk_i8_i32 v221, v106, v110, 0 op_sel:[0,0,0,1]
    v_ashr_pk_i8_i32 v222, v105, v109, 0 op_sel:[0,0,0,1]
    v_ashr_pk_i8_i32 v223, v107, v111, 0 op_sel:[0,0,0,1]
    s_nop 1
    v_permlane32_swap_b32 v220, v222
    v_permlane32_swap_b32 v221, v223
    s_nop 1
    v_permlane16_swap_b32 v220, v221
    v_permlane16_swap_b32 v222, v223
    v_dot4_i32_i8 v227, v220, s54, v227
    v_dot4_i32_i8 v227, v221, s54, v227
    v_dot4_i32_i8 v227, v222, s54, v227
    v_dot4_i32_i8 v227, v223, s54, v227
IFE9:
    s_cmp_eq_u32 s3, 1
    s_cselect_b32 s55, -1, 0
    v_and_b32 v226, s55, v226
    v_add_u32 v227, v227, v226
    s_nop 1
    v_add_u32_dpp v227, v227, v227 row_ror:8 row_mask:0xf bank_mask:0xf
    s_waitcnt lgkmcnt(0)
    s_xor_b64 s[4:5], s[4:5], s[42:43]
    s_xor_b64 s[6:7], s[6:7], s[42:43]
    s_xor_b64 s[8:9], s[8:9], s[42:43]
    s_xor_b64 s[10:11], s[10:11], s[42:43]
    s_xor_b64 s[20:21], s[20:21], s[42:43]
    s_xor_b64 s[22:23], s[22:23], s[42:43]
    s_xor_b64 s[24:25], s[24:25], s[42:43]
    s_xor_b64 s[26:27], s[26:27], s[42:43]
    s_or_b64 s[4:5], s[4:5], s[6:7]
    s_or_b64 s[8:9], s[8:9], s[10:11]
    s_or_b64 s[20:21], s[20:21], s[22:23]
    s_or_b64 s[24:25], s[24:25], s[26:27]
    s_or_b64 s[4:5], s[4:5], s[8:9]
    s_or_b64 s[20:21], s[20:21], s[24:25]
    s_or_b64 s[4:5], s[4:5], s[20:21]
    s_cbranch_scc1 PO1_SLOW
PO1_OK:
    s_cmp_eq_u32 s3, 0
    s_cselect_b32 s43, s43, 0
    s_cselect_b32 s53, s53, 1073741824
    s_add_u32 m0, s60, 36864
    s_nop 0
    buffer_load_dwordx4 v3, s[36:39], m0 offen sc1 lds
    s_add_u32 m0, s60, 69632
    s_nop 0
    buffer_load_dwordx4 v3, s[36:39], m0 offen sc1 lds
    s_add_u32 m0, s60, 102400
    s_nop 0
    buffer_load_dwordx4 v3, s[36:39], m0 offen sc1 lds
    buffer_load_dwordx4 a[8:11], v3, s[16:19], s62 offen offset:2048 sc1
    buffer_load_dwordx4 a[72:75], v3, s[16:19], s63 offen offset:2048 sc1
    s_getpc_b64 s[66:67]
CPF_C:
    s_bfe_u32 s55, s2, 0x30003
    s_lshl_b32 s55, s55, 2
    s_add_u32 s55, s55, s3
    s_lshl_b32 s55, s55, 9
    v_and_b32 v237, 0x1f0, v3
    v_add_u32 v237, s55, v237
    v_min_u32 v237, K_END-CPF_C+1024, v237
    global_load_dword v237, v237, s[66:67]
    s_mov_b64 exec, 1
    buffer_store_dword v235, v232, s[16:19], s52 offen sc1
    s_mov_b64 exec, -1
    s_waitcnt vmcnt(12)
    s_barrier
    ds_read_b128 v[16:19], v244 offset:0
    ds_read_b128 v[20:23], v244 offset:2048
    ds_read_b128 v[24:27], v244 offset:256
    ds_read_b128 v[28:31], v244 offset:2304
    ds_read_b128 v[32:35], v244 offset:32768
    ds_read_b128 v[36:39], v244 offset:34816
    buffer_load_dwordx4 a[12:15], v3, s[16:19], s62 offen offset:3072 sc1
    buffer_load_dwordx4 a[76:79], v3, s[16:19], s63 offen offset:3072 sc1
    buffer_store_dwordx4 v[216:219], v224, s[16:19], 0 offen sc1
    ds_read_b128 v[40:43], v244 offset:33024
    s_waitcnt vmcnt(11) lgkmcnt(3)
    v_mfma_i32_16x16x64_i8 v[120:123], a[0:3], v[16:19], 0
    buffer_store_dwordx4 v[220:223], v225, s[16:19], 0 offen sc1
    v_mfma_i32_16x16x64_i8 v[120:123], a[4:7], v[20:23], v[120:123]
    ds_read_b128 v[44:47], v244 offset:35072
    v_mfma_i32_16x16x64_i8 v[128:131], a[64:67], v[16:19], 0
    buffer_store_short v227, v11, s[16:19], s50 offen sc1
    v_mfma_i32_16x16x64_i8 v[128:131], a[68:71], v[20:23], v[128:131]
    ds_read_b128 v[48:51], v245 offset:0
    s_add_u32 m0, s60, 8192
    v_mfma_i32_16x16x64_i8 v[124:127], a[0:3], v[24:27], 0
    buffer_load_dwordx4 v3, s[36:39], m0 offen sc1 lds
    v_mfma_i32_16x16x64_i8 v[124:127], a[4:7], v[28:31], v[124:127]
    ds_read_b128 v[52:55], v245 offset:2048
    s_add_u32 m0, s60, 40960
    v_mfma_i32_16x16x64_i8 v[132:135], a[64:67], v[24:27], 0
    buffer_load_dwordx4 v3, s[36:39], m0 offen sc1 lds
    v_mfma_i32_16x16x64_i8 v[132:135], a[68:71], v[28:31], v[132:135]
    ds_read_b128 v[56:59], v245 offset:256
    s_waitcnt lgkmcnt(3)
    v_mfma_i32_16x16x64_i8 v[136:139], a[0:3], v[32:35], 0
    s_add_u32 m0, s60, 73728
    v_mfma_i32_16x16x64_i8 v[136:139], a[4:7], v[36:39], v[136:139]
    ds_read_b128 v[60:63], v245 offset:2304
    v_mfma_i32_16x16x64_i8 v[144:147], a[64:67], v[32:35], 0
    buffer_load_dwordx4 v3, s[36:39], m0 offen sc1 lds
    v_mfma_i32_16x16x64_i8 v[144:147], a[68:71], v[36:39], v[144:147]
    ds_read_b128 v[16:19], v245 offset:32768
    s_add_u32 m0, s60, 106496
    v_mfma_i32_16x16x64_i8 v[140:143], a[0:3], v[40:43], 0
    v_mfma_i32_16x16x64_i8 v[140:143], a[4:7], v[44:47], v[140:143]
    ds_read_b128 v[20:23], v245 offset:34816
    v_mfma_i32_16x16x64_i8 v[148:151], a[64:67], v[40:43], 0
    buffer_load_dwordx4 v3, s[36:39], m0 offen sc1 lds
    v_mfma_i32_16x16x64_i8 v[148:151], a[68:71], v[44:47], v[148:151]
    ds_read_b128 v[24:27], v245 offset:33024
    s_waitcnt lgkmcnt(3)
    v_mfma_i32_16x16x64_i8 v[152:155], a[0:3], v[48:51], 0
    s_add_u32 s53, s53, 139264
    buffer_load_dword v236, v233, s[16:19], s53 offen sc1
    s_xor_b32 s62, s62, 4096
    v_mfma_i32_16x16x64_i8 v[152:155], a[4:7], v[52:55], v[152:155]
    ds_read_b128 v[28:31], v245 offset:35072
    v_mfma_i32_16x16x64_i8 v[160:163], a[64:67], v[48:51], 0
    buffer_load_dwordx4 a[16:19], v3, s[16:19], s62 offen offset:0 sc1
    v_mfma_i32_16x16x64_i8 v[160:163], a[68:71], v[52:55], v[160:163]
    s_waitcnt vmcnt(15)
    s_barrier
    ds_read_b128 v[32:35], v244 offset:4096
    v_mfma_i32_16x16x64_i8 v[156:159], a[0:3], v[56:59], 0
    s_xor_b32 s63, s63, 4096
    v_mfma_i32_16x16x64_i8 v[156:159], a[4:7], v[60:63], v[156:159]
    ds_read_b128 v[36:39], v244 offset:6144
    v_mfma_i32_16x16x64_i8 v[164:167], a[64:67], v[56:59], 0
    buffer_load_dwordx4 a[80:83], v3, s[16:19], s63 offen offset:0 sc1
    v_mfma_i32_16x16x64_i8 v[164:167], a[68:71], v[60:63], v[164:167]
    ds_read_b128 v[40:43], v244 offset:4352
    s_waitcnt lgkmcnt(3)
    v_mfma_i32_16x16x64_i8 v[168:171], a[0:3], v[16:19], 0
    v_mfma_i32_16x16x64_i8 v[168:171], a[4:7], v[20:23], v[168:171]
    ds_read_b128 v[44:47], v244 offset:6400
    v_mfma_i32_16x16x64_i8 v[176:179], a[64:67], v[16:19], 0
    buffer_load_dwordx4 a[20:23], v3, s[16:19], s62 offen offset:1024 sc1
    v_mfma_i32_16x16x64_i8 v[176:179], a[68:71], v[20:23], v[176:179]
    ds_read_b128 v[48:51], v244 offset:36864
    v_mfma_i32_16x16x64_i8 v[172:175], a[0:3], v[24:27], 0
    v_mfma_i32_16x16x64_i8 v[172:175], a[4:7], v[28:31], v[172:175]
    ds_read_b128 v[52:55], v244 offset:38912
    v_mfma_i32_16x16x64_i8 v[180:183], a[64:67], v[24:27], 0
    buffer_load_dwordx4 a[84:87], v3, s[16:19], s63 offen offset:1024 sc1
    v_mfma_i32_16x16x64_i8 v[180:183], a[68:71], v[28:31], v[180:183]
    ds_read_b128 v[56:59], v244 offset:37120
    s_waitcnt vmcnt(12) lgkmcnt(3)
    v_mfma_i32_16x16x64_i8 v[120:123], a[8:11], v[32:35], v[120:123]
    s_add_u32 m0, s60, 12288
    v_mfma_i32_16x16x64_i8 v[120:123], a[12:15], v[36:39], v[120:123]
    ds_read_b128 v[60:63], v244 offset:39168
    v_mfma_i32_16x16x64_i8 v[128:131], a[72:75], v[32:35], v[128:131]
    buffer_load_dwordx4 v3, s[36:39], m0 offen sc1 lds
    v_mfma_i32_16x16x64_i8 v[128:131], a[76:79], v[36:39], v[128:131]
    ds_read_b128 v[16:19], v245 offset:4096
    s_add_u32 m0, s60, 45056
    v_mfma_i32_16x16x64_i8 v[124:127], a[8:11], v[40:43], v[124:127]
    buffer_load_dwordx4 v3, s[36:39], m0 offen sc1 lds
    v_mfma_i32_16x16x64_i8 v[124:127], a[12:15], v[44:47], v[124:127]
    ds_read_b128 v[20:23], v245 offset:6144
    s_add_u32 m0, s60, 77824
    v_mfma_i32_16x16x64_i8 v[132:135], a[72:75], v[40:43], v[132:135]
    v_mfma_i32_16x16x64_i8 v[132:135], a[76:79], v[44:47], v[132:135]
    ds_read_b128 v[24:27], v245 offset:4352
    s_waitcnt lgkmcnt(3)
    v_mfma_i32_16x16x64_i8 v[136:139], a[8:11], v[48:51], v[136:139]
    buffer_load_dwordx4 v3, s[36:39], m0 offen sc1 lds
    v_mfma_i32_16x16x64_i8 v[136:139], a[12:15], v[52:55], v[136:139]
    ds_read_b128 v[28:31], v245 offset:6400
    s_add_u32 m0, s60, 110592
    v_mfma_i32_16x16x64_i8 v[144:147], a[72:75], v[48:51], v[144:147]
    v_mfma_i32_16x16x64_i8 v[144:147], a[76:79], v[52:55], v[144:147]
    ds_read_b128 v[32:35], v245 offset:36864
    v_mfma_i32_16x16x64_i8 v[140:143], a[8:11], v[56:59], v[140:143]
    buffer_load_dwordx4 v3, s[36:39], m0 offen sc1 lds
    v_mfma_i32_16x16x64_i8 v[140:143], a[12:15], v[60:63], v[140:143]
    ds_read_b128 v[36:39], v245 offset:38912
    v_mfma_i32_16x16x64_i8 v[148:151], a[72:75], v[56:59], v[148:151]
    v_mfma_i32_16x16x64_i8 v[148:151], a[76:79], v[60:63], v[148:151]
    ds_read_b128 v[40:43], v245 offset:37120
    s_waitcnt lgkmcnt(3)
    v_mfma_i32_16x16x64_i8 v[152:155], a[8:11], v[16:19], v[152:155]
    buffer_load_dwordx4 a[24:27], v3, s[16:19], s62 offen offset:2048 sc1
    v_mfma_i32_16x16x64_i8 v[152:155], a[12:15], v[20:23], v[152:155]
    ds_read_b128 v[44:47], v245 offset:39168
    ds_read2_b32 v[64:65], v248 offset0:0 offset1:32
    v_mfma_i32_16x16x64_i8 v[160:163], a[72:75], v[16:19], v[160:163]
    ds_read2_b32 v[68:69], v248 offset0:16 offset1:48
    ds_read2_b32 v[72:73], v248 offset0:64 offset1:96
    v_mfma_i32_16x16x64_i8 v[160:163], a[76:79], v[20:23], v[160:163]
    s_waitcnt vmcnt(9)
    v_cmp_ne_u32 vcc, s43, v236
    s_cbranch_vccnz PO2_SLOW
PO2_OK:
    s_barrier
    s_cmp_eq_u32 s3, 3
    s_cselect_b32 s33, 7897088, 1073741824
    s_mov_b64 exec, 3
    buffer_store_dword v235, v241, s[16:19], s33 offen sc1
    s_mov_b64 exec, -1
    ds_read_b128 v[48:51], v244 offset:8192
    v_mfma_i32_16x16x64_i8 v[156:159], a[8:11], v[24:27], v[156:159]
    buffer_load_dwordx4 a[88:91], v3, s[16:19], s63 offen offset:2048 sc1
    v_mfma_i32_16x16x64_i8 v[156:159], a[12:15], v[28:31], v[156:159]
    ds_read_b128 v[52:55], v244 offset:10240
    ds_read2_b32 v[76:77], v248 offset0:80 offset1:112
    v_mfma_i32_16x16x64_i8 v[164:167], a[72:75], v[24:27], v[164:167]
    buffer_load_dwordx4 a[28:31], v3, s[16:19], s62 offen offset:3072 sc1
    v_mfma_i32_16x16x64_i8 v[164:167], a[76:79], v[28:31], v[164:167]
    ds_read_b128 v[56:59], v244 offset:8448
    s_waitcnt lgkmcnt(7)
    v_mfma_i32_16x16x64_i8 v[168:171], a[8:11], v[32:35], v[168:171]
    ds_read2_b32 v[80:81], v248 offset0:128 offset1:160
    ds_read2_b32 v[84:85], v248 offset0:144 offset1:176
    v_mfma_i32_16x16x64_i8 v[168:171], a[12:15], v[36:39], v[168:171]
    ds_read_b128 v[60:63], v244 offset:10496
    ds_read2_b32 v[88:89], v249 offset0:192 offset1:224
    v_mfma_i32_16x16x64_i8 v[176:179], a[72:75], v[32:35], v[176:179]
    buffer_load_dwordx4 a[92:95], v3, s[16:19], s63 offen offset:3072 sc1
    v_mfma_i32_16x16x64_i8 v[176:179], a[76:79], v[36:39], v[176:179]
    ds_read_b128 v[16:19], v244 offset:40960
    s_add_u32 m0, s60, 16384
    v_mfma_i32_16x16x64_i8 v[172:175], a[8:11], v[40:43], v[172:175]
    v_add_u32 v248, 1024, v248
    v_add_u32 v249, 1024, v249
    v_mfma_i32_16x16x64_i8 v[172:175], a[12:15], v[44:47], v[172:175]
    ds_read_b128 v[20:23], v244 offset:43008
    v_mfma_i32_16x16x64_i8 v[180:183], a[72:75], v[40:43], v[180:183]
    buffer_load_dwordx4 v3, s[36:39], m0 offen sc1 lds
    v_mfma_i32_16x16x64_i8 v[180:183], a[76:79], v[44:47], v[180:183]
    ds_read_b128 v[24:27], v244 offset:41216
    s_waitcnt vmcnt(10) lgkmcnt(4)
    v_mfma_i32_16x16x64_i8 v[120:123], a[16:19], v[48:51], v[120:123]
    s_add_u32 m0, s60, 49152
    v_mfma_i32_16x16x64_i8 v[120:123], a[20:23], v[52:55], v[120:123]
    ds_read_b128 v[28:31], v244 offset:43264
    v_mfma_i32_16x16x64_i8 v[128:131], a[80:83], v[48:51], v[128:131]
    buffer_load_dwordx4 v3, s[36:39], m0 offen sc1 lds
    v_mfma_i32_16x16x64_i8 v[128:131], a[84:87], v[52:55], v[128:131]
    ds_read_b128 v[32:35], v245 offset:8192
    s_add_u32 m0, s60, 81920
    v_mfma_i32_16x16x64_i8 v[124:127], a[16:19], v[56:59], v[124:127]
    buffer_load_dwordx4 v3, s[36:39], m0 offen sc1 lds
    v_mfma_i32_16x16x64_i8 v[124:127], a[20:23], v[60:63], v[124:127]
    ds_read_b128 v[36:39], v245 offset:10240
    s_add_u32 m0, s60, 114688
    v_mfma_i32_16x16x64_i8 v[132:135], a[80:83], v[56:59], v[132:135]
    v_mfma_i32_16x16x64_i8 v[132:135], a[84:87], v[60:63], v[132:135]
    ds_read_b128 v[40:43], v245 offset:8448
    s_waitcnt lgkmcnt(3)
    v_mfma_i32_16x16x64_i8 v[136:139], a[16:19], v[16:19], v[136:139]
    buffer_load_dwordx4 v3, s[36:39], m0 offen sc1 lds
    v_mfma_i32_16x16x64_i8 v[136:139], a[20:23], v[20:23], v[136:139]
    ds_read_b128 v[44:47], v245 offset:10496
    s_add_u32 s53, s53, 139264
    buffer_load_dword v236, v233, s[16:19], s53 offen sc1
    v_mfma_i32_16x16x64_i8 v[144:147], a[80:83], v[16:19], v[144:147]
    s_xor_b32 s62, s62, 12288
    v_mfma_i32_16x16x64_i8 v[144:147], a[84:87], v[20:23], v[144:147]
    ds_read_b128 v[48:51], v245 offset:40960
    v_mfma_i32_16x16x64_i8 v[140:143], a[16:19], v[24:27], v[140:143]
    buffer_load_dwordx4 a[32:35], v3, s[16:19], s62 offen offset:0 sc1
    v_mfma_i32_16x16x64_i8 v[140:143], a[20:23], v[28:31], v[140:143]
    ds_read_b128 v[52:55], v245 offset:43008
    s_xor_b32 s63, s63, 12288
    v_mfma_i32_16x16x64_i8 v[148:151], a[80:83], v[24:27], v[148:151]
    v_mfma_i32_16x16x64_i8 v[148:151], a[84:87], v[28:31], v[148:151]
    ds_read_b128 v[56:59], v245 offset:41216
    s_waitcnt lgkmcnt(3)
    v_mfma_i32_16x16x64_i8 v[152:155], a[16:19], v[32:35], v[152:155]
    buffer_load_dwordx4 a[96:99], v3, s[16:19], s63 offen offset:0 sc1
    v_mfma_i32_16x16x64_i8 v[152:155], a[20:23], v[36:39], v[152:155]
    ds_read_b128 v[60:63], v245 offset:43264
    v_mfma_i32_16x16x64_i8 v[160:163], a[80:83], v[32:35], v[160:163]
    v_mfma_i32_16x16x64_i8 v[160:163], a[84:87], v[36:39], v[160:163]
    s_waitcnt vmcnt(12)
    s_barrier
    ds_read_b128 v[16:19], v244 offset:12288
    v_mfma_i32_16x16x64_i8 v[156:159], a[16:19], v[40:43], v[156:159]
    buffer_load_dwordx4 a[36:39], v3, s[16:19], s62 offen offset:1024 sc1
    v_mfma_i32_16x16x64_i8 v[156:159], a[20:23], v[44:47], v[156:159]
    ds_read_b128 v[20:23], v244 offset:14336
    v_mfma_i32_16x16x64_i8 v[164:167], a[80:83], v[40:43], v[164:167]
    v_mfma_i32_16x16x64_i8 v[164:167], a[84:87], v[44:47], v[164:167]
    ds_read_b128 v[24:27], v244 offset:12544
    s_waitcnt lgkmcnt(3)
    v_mfma_i32_16x16x64_i8 v[168:171], a[16:19], v[48:51], v[168:171]
    buffer_load_dwordx4 a[100:103], v3, s[16:19], s63 offen offset:1024 sc1
    v_mfma_i32_16x16x64_i8 v[168:171], a[20:23], v[52:55], v[168:171]
    ds_read_b128 v[28:31], v244 offset:14592
    s_add_u32 m0, s60, 20480
    v_mfma_i32_16x16x64_i8 v[176:179], a[80:83], v[48:51], v[176:179]
    v_mfma_i32_16x16x64_i8 v[176:179], a[84:87], v[52:55], v[176:179]
    ds_read_b128 v[32:35], v244 offset:45056
    v_mfma_i32_16x16x64_i8 v[172:175], a[16:19], v[56:59], v[172:175]
    buffer_load_dwordx4 v3, s[36:39], m0 offen sc1 lds
    v_mfma_i32_16x16x64_i8 v[172:175], a[20:23], v[60:63], v[172:175]
    ds_read_b128 v[36:39], v244 offset:47104
    s_add_u32 m0, s60, 53248
    v_mfma_i32_16x16x64_i8 v[180:183], a[80:83], v[56:59], v[180:183]
    v_mfma_i32_16x16x64_i8 v[180:183], a[84:87], v[60:63], v[180:183]
    ds_read_b128 v[40:43], v244 offset:45312
    s_waitcnt vmcnt(10) lgkmcnt(3)
    v_mfma_i32_16x16x64_i8 v[120:123], a[24:27], v[16:19], v[120:123]
    buffer_load_dwordx4 v3, s[36:39], m0 offen sc1 lds
    v_mfma_i32_16x16x64_i8 v[120:123], a[28:31], v[20:23], v[120:123]
    ds_read_b128 v[44:47], v244 offset:47360
    v_mfma_i32_16x16x64_i8 v[128:131], a[88:91], v[16:19], v[128:131]
    buffer_load_dwordx4 a[40:43], v3, s[16:19], s62 offen offset:2048 sc1
    v_mfma_i32_16x16x64_i8 v[128:131], a[92:95], v[20:23], v[128:131]
    ds_read_b128 v[48:51], v245 offset:12288
    v_mfma_i32_16x16x64_i8 v[124:127], a[24:27], v[24:27], v[124:127]
    v_mfma_i32_16x16x64_i8 v[124:127], a[28:31], v[28:31], v[124:127]
    ds_read_b128 v[52:55], v245 offset:14336
    v_mfma_i32_16x16x64_i8 v[132:135], a[88:91], v[24:27], v[132:135]
    buffer_load_dwordx4 a[104:107], v3, s[16:19], s63 offen offset:2048 sc1
    v_mfma_i32_16x16x64_i8 v[132:135], a[92:95], v[28:31], v[132:135]
    ds_read_b128 v[56:59], v245 offset:12544
    s_waitcnt lgkmcnt(3)
    v_mfma_i32_16x16x64_i8 v[136:139], a[24:27], v[32:35], v[136:139]
    v_mfma_i32_16x16x64_i8 v[136:139], a[28:31], v[36:39], v[136:139]
    ds_read_b128 v[60:63], v245 offset:14592
    v_mfma_i32_16x16x64_i8 v[144:147], a[88:91], v[32:35], v[144:147]
    buffer_load_dwordx4 a[44:47], v3, s[16:19], s62 offen offset:3072 sc1
    v_mfma_i32_16x16x64_i8 v[144:147], a[92:95], v[36:39], v[144:147]
    ds_read_b128 v[16:19], v245 offset:45056
    v_mfma_i32_16x16x64_i8 v[140:143], a[24:27], v[40:43], v[140:143]
    v_mfma_i32_16x16x64_i8 v[140:143], a[28:31], v[44:47], v[140:143]
    ds_read_b128 v[20:23], v245 offset:47104
    v_mfma_i32_16x16x64_i8 v[148:151], a[88:91], v[40:43], v[148:151]
    buffer_load_dwordx4 a[108:111], v3, s[16:19], s63 offen offset:3072 sc1
    v_mfma_i32_16x16x64_i8 v[148:151], a[92:95], v[44:47], v[148:151]
    ds_read_b128 v[24:27], v245 offset:45312
    s_waitcnt lgkmcnt(3)
    v_mfma_i32_16x16x64_i8 v[152:155], a[24:27], v[48:51], v[152:155]
    v_mfma_i32_16x16x64_i8 v[152:155], a[28:31], v[52:55], v[152:155]
    ds_read_b128 v[28:31], v245 offset:47360
    v_mfma_i32_16x16x64_i8 v[160:163], a[88:91], v[48:51], v[160:163]
    v_mfma_i32_16x16x64_i8 v[160:163], a[92:95], v[52:55], v[160:163]
    s_waitcnt vmcnt(10)
    v_cmp_ne_u32 vcc, s43, v236
    s_cbranch_vccnz PO3_SLOW
PO3_OK:
    s_barrier
    ds_read_b128 v[32:35], v244 offset:16384
    v_mfma_i32_16x16x64_i8 v[156:159], a[24:27], v[56:59], v[156:159]
    s_add_u32 m0, s60, 24576
    v_mfma_i32_16x16x64_i8 v[156:159], a[28:31], v[60:63], v[156:159]
    ds_read_b128 v[36:39], v244 offset:18432
    v_mfma_i32_16x16x64_i8 v[164:167], a[88:91], v[56:59], v[164:167]
    buffer_load_dwordx4 v3, s[36:39], m0 offen sc1 lds
    v_mfma_i32_16x16x64_i8 v[164:167], a[92:95], v[60:63], v[164:167]
    ds_read_b128 v[40:43], v244 offset:16640
    s_waitcnt lgkmcnt(3)
    v_mfma_i32_16x16x64_i8 v[168:171], a[24:27], v[16:19], v[168:171]
    s_add_u32 m0, s60, 57344
    v_mfma_i32_16x16x64_i8 v[168:171], a[28:31], v[20:23], v[168:171]
    ds_read_b128 v[44:47], v244 offset:18688
    v_mfma_i32_16x16x64_i8 v[176:179], a[88:91], v[16:19], v[176:179]
    buffer_load_dwordx4 v3, s[36:39], m0 offen sc1 lds
    v_mfma_i32_16x16x64_i8 v[176:179], a[92:95], v[20:23], v[176:179]
    ds_read_b128 v[48:51], v244 offset:49152
    s_add_u32 m0, s60, 86016
    v_mfma_i32_16x16x64_i8 v[172:175], a[24:27], v[24:27], v[172:175]
    v_mfma_i32_16x16x64_i8 v[172:175], a[28:31], v[28:31], v[172:175]
    ds_read_b128 v[52:55], v244 offset:51200
    v_mfma_i32_16x16x64_i8 v[180:183], a[88:91], v[24:27], v[180:183]
    buffer_load_dwordx4 v3, s[36:39], m0 offen sc1 lds
    v_mfma_i32_16x16x64_i8 v[180:183], a[92:95], v[28:31], v[180:183]
    ds_read_b128 v[56:59], v244 offset:49408
    s_waitcnt vmcnt(9) lgkmcnt(3)
    v_mfma_i32_16x16x64_i8 v[120:123], a[32:35], v[32:35], v[120:123]
    s_add_u32 m0, s60, 118784
    v_mfma_i32_16x16x64_i8 v[120:123], a[36:39], v[36:39], v[120:123]
    ds_read_b128 v[60:63], v244 offset:51456
    v_mfma_i32_16x16x64_i8 v[128:131], a[96:99], v[32:35], v[128:131]
    buffer_load_dwordx4 v3, s[36:39], m0 offen sc1 lds
    v_mfma_i32_16x16x64_i8 v[128:131], a[100:103], v[36:39], v[128:131]
    ds_read_b128 v[16:19], v245 offset:16384
    s_add_u32 s53, s53, 139264
    buffer_load_dword v236, v234, s[16:19], s53 offen sc1
    v_mfma_i32_16x16x64_i8 v[124:127], a[32:35], v[40:43], v[124:127]
    s_xor_b32 s62, s62, 4096
    v_mfma_i32_16x16x64_i8 v[124:127], a[36:39], v[44:47], v[124:127]
    ds_read_b128 v[20:23], v245 offset:18432
    v_mfma_i32_16x16x64_i8 v[132:135], a[96:99], v[40:43], v[132:135]
    buffer_load_dwordx4 a[48:51], v3, s[16:19], s62 offen offset:0 sc1
    v_mfma_i32_16x16x64_i8 v[132:135], a[100:103], v[44:47], v[132:135]
    ds_read_b128 v[24:27], v245 offset:16640
    s_waitcnt lgkmcnt(3)
    v_mfma_i32_16x16x64_i8 v[136:139], a[32:35], v[48:51], v[136:139]
    s_xor_b32 s63, s63, 4096
ISL1:
    s_cbranch_vccnz ISL2
    v_mfma_i32_16x16x64_i8 v[136:139], a[36:39], v[52:55], v[136:139]
    ds_read_b128 v[28:31], v245 offset:18688
    v_mfma_i32_16x16x64_i8 v[144:147], a[96:99], v[48:51], v[144:147]
    buffer_load_dwordx4 a[112:115], v3, s[16:19], s63 offen offset:0 sc1
    v_mfma_i32_16x16x64_i8 v[144:147], a[100:103], v[52:55], v[144:147]
    ds_read_b128 v[32:35], v245 offset:49152
    v_mfma_i32_16x16x64_i8 v[140:143], a[32:35], v[56:59], v[140:143]
    v_mfma_i32_16x16x64_i8 v[140:143], a[36:39], v[60:63], v[140:143]
    ds_read_b128 v[36:39], v245 offset:51200
    v_mfma_i32_16x16x64_i8 v[148:151], a[96:99], v[56:59], v[148:151]
    buffer_load_dwordx4 a[52:55], v3, s[16:19], s62 offen offset:1024 sc1
    v_mfma_i32_16x16x64_i8 v[148:151], a[100:103], v[60:63], v[148:151]
    ds_read_b128 v[40:43], v245 offset:49408
    s_waitcnt lgkmcnt(3)
    v_mfma_i32_16x16x64_i8 v[152:155], a[32:35], v[16:19], v[152:155]
    v_mfma_i32_16x16x64_i8 v[152:155], a[36:39], v[20:23], v[152:155]
    ds_read_b128 v[44:47], v245 offset:51456
    v_mfma_i32_16x16x64_i8 v[160:163], a[96:99], v[16:19], v[160:163]
    buffer_load_dwordx4 a[116:119], v3, s[16:19], s63 offen offset:1024 sc1
    v_mfma_i32_16x16x64_i8 v[160:163], a[100:103], v[20:23], v[160:163]
    s_waitcnt vmcnt(13)
    s_barrier
    ds_read_b128 v[48:51], v244 offset:20480
    v_mfma_i32_16x16x64_i8 v[156:159], a[32:35], v[24:27], v[156:159]
    s_add_u32 m0, s60, 28672
    v_mfma_i32_16x16x64_i8 v[156:159], a[36:39], v[28:31], v[156:159]
    ds_read_b128 v[52:55], v244 offset:22528
    v_mfma_i32_16x16x64_i8 v[164:167], a[96:99], v[24:27], v[164:167]
    buffer_load_dwordx4 v3, s[36:39], m0 offen sc1 lds
    v_mfma_i32_16x16x64_i8 v[164:167], a[100:103], v[28:31], v[164:167]
    ds_read_b128 v[56:59], v244 offset:20736
    s_waitcnt lgkmcnt(3)
    v_mfma_i32_16x16x64_i8 v[168:171], a[32:35], v[32:35], v[168:171]
    s_add_u32 m0, s60, 61440
    v_mfma_i32_16x16x64_i8 v[168:171], a[36:39], v[36:39], v[168:171]
    ds_read_b128 v[60:63], v244 offset:22784
    v_mfma_i32_16x16x64_i8 v[176:179], a[96:99], v[32:35], v[176:179]
    buffer_load_dwordx4 v3, s[36:39], m0 offen sc1 lds
    v_mfma_i32_16x16x64_i8 v[176:179], a[100:103], v[36:39], v[176:179]
    ds_read_b128 v[16:19], v244 offset:53248
    s_add_u32 m0, s60, 90112
    v_mfma_i32_16x16x64_i8 v[172:175], a[32:35], v[40:43], v[172:175]
    v_mfma_i32_16x16x64_i8 v[172:175], a[36:39], v[44:47], v[172:175]
    ds_read_b128 v[20:23], v244 offset:55296
    v_mfma_i32_16x16x64_i8 v[180:183], a[96:99], v[40:43], v[180:183]
    buffer_load_dwordx4 v3, s[36:39], m0 offen sc1 lds
    v_mfma_i32_16x16x64_i8 v[180:183], a[100:103], v[44:47], v[180:183]
    ds_read_b128 v[24:27], v244 offset:53504
    s_waitcnt vmcnt(12) lgkmcnt(3)
    v_mfma_i32_16x16x64_i8 v[120:123], a[40:43], v[48:51], v[120:123]
    s_add_u32 m0, s60, 122880
    v_mfma_i32_16x16x64_i8 v[120:123], a[44:47], v[52:55], v[120:123]
    ds_read_b128 v[28:31], v244 offset:55552
    v_mfma_i32_16x16x64_i8 v[128:131], a[104:107], v[48:51], v[128:131]
    buffer_load_dwordx4 v3, s[36:39], m0 offen sc1 lds
    v_mfma_i32_16x16x64_i8 v[128:131], a[108:111], v[52:55], v[128:131]
    s_waitcnt vmcnt(8)
    v_cmp_ne_u32 vcc, s43, v236
    s_cbranch_vccnz PO4_SLOW
PO4_OK:
    s_barrier
    ds_read_b128 v[32:35], v244 offset:24576
    v_mfma_i32_16x16x64_i8 v[124:127], a[40:43], v[56:59], v[124:127]
    buffer_load_dwordx2 v[96:97], v251, s[16:19], s32 offen offset:0 sc1
    v_mfma_i32_16x16x64_i8 v[124:127], a[44:47], v[60:63], v[124:127]
    ds_read_b128 v[36:39], v244 offset:26624
    v_mfma_i32_16x16x64_i8 v[132:135], a[104:107], v[56:59], v[132:135]
    buffer_load_dwordx2 v[98:99], v251, s[16:19], s32 offen offset:512 sc1
    v_mfma_i32_16x16x64_i8 v[132:135], a[108:111], v[60:63], v[132:135]
    ds_read_b128 v[40:43], v244 offset:24832
    s_waitcnt lgkmcnt(3)
    v_mfma_i32_16x16x64_i8 v[136:139], a[40:43], v[16:19], v[136:139]
    buffer_load_dwordx2 v[100:101], v251, s[16:19], s32 offen offset:1024 sc1
    v_mfma_i32_16x16x64_i8 v[136:139], a[44:47], v[20:23], v[136:139]
    ds_read_b128 v[44:47], v244 offset:26880
    v_mfma_i32_16x16x64_i8 v[144:147], a[104:107], v[16:19], v[144:147]
    buffer_load_dwordx2 v[102:103], v251, s[16:19], s32 offen offset:1536 sc1
    v_mfma_i32_16x16x64_i8 v[144:147], a[108:111], v[20:23], v[144:147]
    ds_read_b128 v[48:51], v244 offset:57344
    v_mfma_i32_16x16x64_i8 v[140:143], a[40:43], v[24:27], v[140:143]
    buffer_load_dwordx4 a[56:59], v3, s[16:19], s62 offen offset:2048 sc1
    v_mfma_i32_16x16x64_i8 v[140:143], a[44:47], v[28:31], v[140:143]
    ds_read_b128 v[52:55], v244 offset:59392
    v_mfma_i32_16x16x64_i8 v[148:151], a[104:107], v[24:27], v[148:151]
    v_mfma_i32_16x16x64_i8 v[148:151], a[108:111], v[28:31], v[148:151]
    ds_read_b128 v[56:59], v244 offset:57600
    s_waitcnt vmcnt(9) lgkmcnt(3)
    v_mfma_i32_16x16x64_i8 v[120:123], a[48:51], v[32:35], v[120:123]
    buffer_load_dwordx4 a[120:123], v3, s[16:19], s63 offen offset:2048 sc1
    v_mfma_i32_16x16x64_i8 v[120:123], a[52:55], v[36:39], v[120:123]
    ds_read_b128 v[60:63], v244 offset:59648
    v_mfma_i32_16x16x64_i8 v[128:131], a[112:115], v[32:35], v[128:131]
    buffer_load_dwordx4 a[60:63], v3, s[16:19], s62 offen offset:3072 sc1
    v_mfma_i32_16x16x64_i8 v[128:131], a[116:119], v[36:39], v[128:131]
    ds_read_b128 v[16:19], v245 offset:20480
    v_mfma_i32_16x16x64_i8 v[124:127], a[48:51], v[40:43], v[124:127]
    buffer_load_dwordx4 a[124:127], v3, s[16:19], s63 offen offset:3072 sc1
    v_mfma_i32_16x16x64_i8 v[124:127], a[52:55], v[44:47], v[124:127]
    ds_read_b128 v[20:23], v245 offset:22528
    s_add_u32 m0, s60, 94208
    v_mfma_i32_16x16x64_i8 v[132:135], a[112:115], v[40:43], v[132:135]
    buffer_load_dwordx4 v3, s[36:39], m0 offen sc1 lds
    v_mfma_i32_16x16x64_i8 v[132:135], a[116:119], v[44:47], v[132:135]
    ds_read_b128 v[24:27], v245 offset:20736
    s_waitcnt lgkmcnt(3)
    v_mfma_i32_16x16x64_i8 v[136:139], a[48:51], v[48:51], v[136:139]
    s_add_u32 m0, s60, 126976
    v_mfma_i32_16x16x64_i8 v[136:139], a[52:55], v[52:55], v[136:139]
    ds_read_b128 v[28:31], v245 offset:22784
    v_mfma_i32_16x16x64_i8 v[144:147], a[112:115], v[48:51], v[144:147]
    buffer_load_dwordx4 v3, s[36:39], m0 offen sc1 lds
    v_mfma_i32_16x16x64_i8 v[144:147], a[116:119], v[52:55], v[144:147]
    ds_read_b128 v[32:35], v245 offset:53248
    s_add_u32 s44, s61, 131072
    v_mfma_i32_16x16x64_i8 v[140:143], a[48:51], v[56:59], v[140:143]
    s_add_u32 m0, s61, 0
    v_mfma_i32_16x16x64_i8 v[140:143], a[52:55], v[60:63], v[140:143]
    ds_read_b128 v[36:39], v245 offset:55296
    v_mfma_i32_16x16x64_i8 v[148:151], a[112:115], v[56:59], v[148:151]
    buffer_load_dwordx4 v3, s[36:39], s44 offen sc1 lds
    v_mfma_i32_16x16x64_i8 v[148:151], a[116:119], v[60:63], v[148:151]
    ds_read_b128 v[40:43], v245 offset:53504
    s_waitcnt lgkmcnt(3)
    v_mfma_i32_16x16x64_i8 v[152:155], a[40:43], v[16:19], v[152:155]
    v_mfma_i32_16x16x64_i8 v[152:155], a[44:47], v[20:23], v[152:155]
    ds_read_b128 v[44:47], v245 offset:55552
    v_mfma_i32_16x16x64_i8 v[160:163], a[104:107], v[16:19], v[160:163]
    buffer_load_dwordx4 v3, s[36:39], s44 offen offset:1024 sc1 lds
    v_mfma_i32_16x16x64_i8 v[160:163], a[108:111], v[20:23], v[160:163]
    s_waitcnt vmcnt(12)
    s_barrier
    ds_read_b128 v[48:51], v244 offset:28672
    v_mfma_i32_16x16x64_i8 v[156:159], a[40:43], v[24:27], v[156:159]
    buffer_load_dwordx4 v3, s[36:39], s44 offen offset:2048 sc1 lds
    v_mfma_i32_16x16x64_i8 v[156:159], a[44:47], v[28:31], v[156:159]
    ds_read_b128 v[52:55], v244 offset:30720
    v_mfma_i32_16x16x64_i8 v[164:167], a[104:107], v[24:27], v[164:167]
    v_mfma_i32_16x16x64_i8 v[164:167], a[108:111], v[28:31], v[164:167]
    ds_read_b128 v[56:59], v244 offset:28928
    s_waitcnt lgkmcnt(3)
    v_mfma_i32_16x16x64_i8 v[168:171], a[40:43], v[32:35], v[168:171]
    buffer_load_dwordx4 v3, s[36:39], s44 offen offset:3072 sc1 lds
    v_mfma_i32_16x16x64_i8 v[168:171], a[44:47], v[36:39], v[168:171]
    ds_read_b128 v[60:63], v244 offset:30976
    s_add_u32 s44, s61, 147456
    v_mfma_i32_16x16x64_i8 v[176:179], a[104:107], v[32:35], v[176:179]
    s_add_u32 m0, s61, 32768
    v_mfma_i32_16x16x64_i8 v[176:179], a[108:111], v[36:39], v[176:179]
    s_waitcnt vmcnt(10)
    v_pk_add_i16 v96, v96, v100
    v_pk_add_i16 v97, v97, v101
    v_pk_add_i16 v98, v98, v102
    v_pk_add_i16 v99, v99, v103
    v_pk_add_i16 v96, v96, v98
    v_pk_add_i16 v97, v97, v99
    v_bfe_i32 v92, v96, 0, 16
    v_ashrrev_i32 v93, 16, v96
    v_bfe_i32 v94, v97, 0, 16
    v_ashrrev_i32 v95, 16, v97
    v_permlane32_swap_b32 v92, v93
    s_nop 0
    v_permlane32_swap_b32 v94, v95
    v_add_u32 v92, v92, v93
    v_add_u32 v94, v94, v95
    s_nop 1
    v_permlane16_swap_b32 v92, v94
    v_add_u32 v92, v92, v94
    v_cvt_f32_i32 v92, v92
    v_cvt_pk_bf16_f32 v92, v92, v92
    v_lshlrev_b32 v92, 16, v92
    v_mul_f32 v92, v92, v252
    v_cvt_pk_bf16_f32 v92, v92, v92
    v_lshlrev_b32 v92, 16, v92
    v_fma_f32 v239, -v92, v238, v239
    ds_write_b32 v250, v239 offset:1024
    ds_read_b128 v[16:19], v244 offset:61440
    v_mfma_i32_16x16x64_i8 v[172:175], a[40:43], v[40:43], v[172:175]
    buffer_load_dwordx4 v3, s[36:39], s44 offen sc1 lds
    v_mfma_i32_16x16x64_i8 v[172:175], a[44:47], v[44:47], v[172:175]
    ds_read_b128 v[20:23], v244 offset:63488
    v_mfma_i32_16x16x64_i8 v[180:183], a[104:107], v[40:43], v[180:183]
    v_mfma_i32_16x16x64_i8 v[180:183], a[108:111], v[44:47], v[180:183]
    ds_read_b128 v[24:27], v244 offset:61696
    s_waitcnt vmcnt(7) lgkmcnt(4)
    v_mfma_i32_16x16x64_i8 v[120:123], a[56:59], v[48:51], v[120:123]
    buffer_load_dwordx4 v3, s[36:39], s44 offen offset:1024 sc1 lds
    v_mfma_i32_16x16x64_i8 v[120:123], a[60:63], v[52:55], v[120:123]
    ds_read_b128 v[28:31], v244 offset:63744
    v_mfma_i32_16x16x64_i8 v[128:131], a[120:123], v[48:51], v[128:131]
    buffer_load_dwordx4 v3, s[36:39], s44 offen offset:2048 sc1 lds
    v_mfma_i32_16x16x64_i8 v[128:131], a[124:127], v[52:55], v[128:131]
    ds_read_b128 v[32:35], v245 offset:24576
    v_mfma_i32_16x16x64_i8 v[124:127], a[56:59], v[56:59], v[124:127]
    buffer_load_dwordx4 v3, s[36:39], s44 offen offset:3072 sc1 lds
    v_mfma_i32_16x16x64_i8 v[124:127], a[60:63], v[60:63], v[124:127]
    ds_read_b128 v[36:39], v245 offset:26624
    s_add_u32 s44, s61, 163840
    v_mfma_i32_16x16x64_i8 v[132:135], a[120:123], v[56:59], v[132:135]
    s_add_u32 m0, s61, 65536
    v_mfma_i32_16x16x64_i8 v[132:135], a[124:127], v[60:63], v[132:135]
    ds_read_b128 v[40:43], v245 offset:24832
    s_waitcnt lgkmcnt(3)
    v_mfma_i32_16x16x64_i8 v[136:139], a[56:59], v[16:19], v[136:139]
    buffer_load_dwordx4 v3, s[36:39], s44 offen sc1 lds
    v_mfma_i32_16x16x64_i8 v[136:139], a[60:63], v[20:23], v[136:139]
    ds_read_b128 v[44:47], v245 offset:26880
    v_mfma_i32_16x16x64_i8 v[144:147], a[120:123], v[16:19], v[144:147]
    v_mfma_i32_16x16x64_i8 v[144:147], a[124:127], v[20:23], v[144:147]
    ds_read_b128 v[48:51], v245 offset:57344
    v_mfma_i32_16x16x64_i8 v[140:143], a[56:59], v[24:27], v[140:143]
    buffer_load_dwordx4 v3, s[36:39], s44 offen offset:1024 sc1 lds
    v_mfma_i32_16x16x64_i8 v[140:143], a[60:63], v[28:31], v[140:143]
    ds_read_b128 v[52:55], v245 offset:59392
    v_mfma_i32_16x16x64_i8 v[148:151], a[120:123], v[24:27], v[148:151]
    v_mfma_i32_16x16x64_i8 v[148:151], a[124:127], v[28:31], v[148:151]
    ds_read_b128 v[56:59], v245 offset:57600
    s_waitcnt lgkmcnt(3)
    v_mfma_i32_16x16x64_i8 v[152:155], a[48:51], v[32:35], v[152:155]
    buffer_load_dwordx4 v3, s[36:39], s44 offen offset:2048 sc1 lds
    v_mfma_i32_16x16x64_i8 v[152:155], a[52:55], v[36:39], v[152:155]
    ds_read_b128 v[60:63], v245 offset:59648
    v_mfma_i32_16x16x64_i8 v[160:163], a[112:115], v[32:35], v[160:163]
    v_mfma_i32_16x16x64_i8 v[160:163], a[116:119], v[36:39], v[160:163]
    s_waitcnt vmcnt(11)
    s_barrier
    ds_read_b128 v[16:19], v245 offset:28672
    v_mfma_i32_16x16x64_i8 v[156:159], a[48:51], v[40:43], v[156:159]
    buffer_load_dwordx4 v3, s[36:39], s44 offen offset:3072 sc1 lds
    v_mfma_i32_16x16x64_i8 v[156:159], a[52:55], v[44:47], v[156:159]
    ds_read_b128 v[20:23], v245 offset:30720
    s_add_u32 s44, s61, 180224
    v_mfma_i32_16x16x64_i8 v[164:167], a[112:115], v[40:43], v[164:167]
    s_add_u32 m0, s61, 98304
    ds_read2_b32 v[66:67], v248 offset0:0 offset1:32
    v_mfma_i32_16x16x64_i8 v[164:167], a[116:119], v[44:47], v[164:167]
    ds_read_b128 v[24:27], v245 offset:28928
    s_waitcnt lgkmcnt(4)
    v_mfma_i32_16x16x64_i8 v[168:171], a[48:51], v[48:51], v[168:171]
    buffer_load_dwordx4 v3, s[36:39], s44 offen sc1 lds
    v_mfma_i32_16x16x64_i8 v[168:171], a[52:55], v[52:55], v[168:171]
    ds_read_b128 v[28:31], v245 offset:30976
    ds_read2_b32 v[70:71], v248 offset0:16 offset1:48
    v_mfma_i32_16x16x64_i8 v[176:179], a[112:115], v[48:51], v[176:179]
    buffer_load_dwordx4 v3, s[36:39], s44 offen offset:1024 sc1 lds
    v_mfma_i32_16x16x64_i8 v[176:179], a[116:119], v[52:55], v[176:179]
    ds_read_b128 v[32:35], v245 offset:61440
    ds_read2_b32 v[74:75], v248 offset0:64 offset1:96
    v_mfma_i32_16x16x64_i8 v[172:175], a[48:51], v[56:59], v[172:175]
    buffer_load_dwordx4 v3, s[36:39], s44 offen offset:2048 sc1 lds
    v_mfma_i32_16x16x64_i8 v[172:175], a[52:55], v[60:63], v[172:175]
    ds_read_b128 v[36:39], v245 offset:63488
    ds_read2_b32 v[78:79], v248 offset0:80 offset1:112
    v_mfma_i32_16x16x64_i8 v[180:183], a[112:115], v[56:59], v[180:183]
    buffer_load_dwordx4 v3, s[36:39], s44 offen offset:3072 sc1 lds
    v_mfma_i32_16x16x64_i8 v[180:183], a[116:119], v[60:63], v[180:183]
    ds_read_b128 v[40:43], v245 offset:61696
    s_waitcnt lgkmcnt(6)
    v_mfma_i32_16x16x64_i8 v[152:155], a[56:59], v[16:19], v[152:155]
    ds_read2_b32 v[82:83], v248 offset0:128 offset1:160
    ds_read2_b32 v[86:87], v248 offset0:144 offset1:176
    v_mfma_i32_16x16x64_i8 v[152:155], a[60:63], v[20:23], v[152:155]
    ds_read_b128 v[44:47], v245 offset:63744
    ds_read2_b32 v[90:91], v249 offset0:192 offset1:224
    v_mfma_i32_16x16x64_i8 v[160:163], a[120:123], v[16:19], v[160:163]
    v_cvt_f32_i32 v120, v120
    v_cvt_f32_i32 v124, v124
    v_mfma_i32_16x16x64_i8 v[160:163], a[124:127], v[20:23], v[160:163]
    s_waitcnt vmcnt(12)
    s_barrier
    ds_read_b128 v[48:51], v244 offset:0
    v_mfma_i32_16x16x64_i8 v[156:159], a[56:59], v[24:27], v[156:159]
    s_add_u32 s44, s61, 196608
    s_add_u32 m0, s61, 16384
    v_mfma_i32_16x16x64_i8 v[156:159], a[60:63], v[28:31], v[156:159]
    ds_read_b128 v[52:55], v244 offset:2048
    v_fma_f32 v120, v120, v64, v66
    v_mfma_i32_16x16x64_i8 v[164:167], a[120:123], v[24:27], v[164:167]
    buffer_load_dwordx4 v3, s[36:39], s44 offen sc1 lds
    v_mfma_i32_16x16x64_i8 v[164:167], a[124:127], v[28:31], v[164:167]
    ds_read_b128 v[56:59], v244 offset:256
    s_waitcnt lgkmcnt(4)
    v_mfma_i32_16x16x64_i8 v[168:171], a[56:59], v[32:35], v[168:171]
    v_fma_f32 v124, v124, v65, v67
    v_cvt_pk_bf16_f32 v92, v120, v124
    v_mfma_i32_16x16x64_i8 v[168:171], a[60:63], v[36:39], v[168:171]
    ds_read_b128 v[60:63], v244 offset:2304
    v_cvt_f32_i32 v136, v136
    v_mfma_i32_16x16x64_i8 v[176:179], a[120:123], v[32:35], v[176:179]
    v_cvt_f32_i32 v140, v140
    v_fma_f32 v136, v136, v68, v70
    v_mfma_i32_16x16x64_i8 v[176:179], a[124:127], v[36:39], v[176:179]
    ds_read_b128 v[16:19], v244 offset:4096
    v_fma_f32 v140, v140, v69, v71
    v_mfma_i32_16x16x64_i8 v[172:175], a[56:59], v[40:43], v[172:175]
    buffer_load_dwordx4 v3, s[36:39], s44 offen offset:1024 sc1 lds
    v_mfma_i32_16x16x64_i8 v[172:175], a[60:63], v[44:47], v[172:175]
    ds_read_b128 v[20:23], v244 offset:6144
    v_cvt_pk_bf16_f32 v93, v136, v140
    v_mfma_i32_16x16x64_i8 v[180:183], a[120:123], v[40:43], v[180:183]
    buffer_store_dwordx2 v[92:93], v246, s[28:31], s68 offen offset:0 sc1 nt
    v_cvt_f32_i32 v121, v121
    v_mfma_i32_16x16x64_i8 v[180:183], a[124:127], v[44:47], v[180:183]
    ds_read_b128 v[24:27], v244 offset:4352
    s_waitcnt lgkmcnt(3)
    v_mfma_i32_16x16x64_i8 v[184:187], a[0:3], v[48:51], 0
    v_cvt_f32_i32 v125, v125
    v_fma_f32 v121, v121, v64, v66
    v_mfma_i32_16x16x64_i8 v[184:187], a[4:7], v[52:55], v[184:187]
    ds_read_b128 v[28:31], v244 offset:6400
    v_fma_f32 v125, v125, v65, v67
    v_mfma_i32_16x16x64_i8 v[192:195], a[64:67], v[48:51], 0
    v_cvt_pk_bf16_f32 v94, v121, v125
    v_cvt_f32_i32 v137, v137
    v_mfma_i32_16x16x64_i8 v[192:195], a[68:71], v[52:55], v[192:195]
    ds_read_b128 v[32:35], v244 offset:8192
    v_cvt_f32_i32 v141, v141
    v_mfma_i32_16x16x64_i8 v[188:191], a[0:3], v[56:59], 0
    v_fma_f32 v137, v137, v68, v70
    v_fma_f32 v141, v141, v69, v71
    v_mfma_i32_16x16x64_i8 v[188:191], a[4:7], v[60:63], v[188:191]
    ds_read_b128 v[36:39], v244 offset:10240
    v_cvt_pk_bf16_f32 v95, v137, v141
    v_mfma_i32_16x16x64_i8 v[196:199], a[64:67], v[56:59], 0
    buffer_store_dwordx2 v[94:95], v246, s[28:31], s69 offen offset:0 sc1 nt
    v_cvt_f32_i32 v122, v122
    v_mfma_i32_16x16x64_i8 v[196:199], a[68:71], v[60:63], v[196:199]
    ds_read_b128 v[40:43], v244 offset:8448
    s_waitcnt lgkmcnt(3)
    v_mfma_i32_16x16x64_i8 v[184:187], a[8:11], v[16:19], v[184:187]
    v_cvt_f32_i32 v126, v126
    v_fma_f32 v122, v122, v64, v66
    v_mfma_i32_16x16x64_i8 v[184:187], a[12:15], v[20:23], v[184:187]
    ds_read_b128 v[44:47], v244 offset:10496
    v_fma_f32 v126, v126, v65, v67
    v_mfma_i32_16x16x64_i8 v[192:195], a[72:75], v[16:19], v[192:195]
    v_cvt_pk_bf16_f32 v96, v122, v126
    v_cvt_f32_i32 v138, v138
    v_mfma_i32_16x16x64_i8 v[192:195], a[76:79], v[20:23], v[192:195]
    ds_read_b128 v[48:51], v244 offset:12288
    v_cvt_f32_i32 v142, v142
    v_mfma_i32_16x16x64_i8 v[188:191], a[8:11], v[24:27], v[188:191]
    v_fma_f32 v138, v138, v68, v70
    v_fma_f32 v142, v142, v69, v71
    v_mfma_i32_16x16x64_i8 v[188:191], a[12:15], v[28:31], v[188:191]
    ds_read_b128 v[52:55], v244 offset:14336
    v_cvt_pk_bf16_f32 v97, v138, v142
    v_mfma_i32_16x16x64_i8 v[196:199], a[72:75], v[24:27], v[196:199]
    buffer_store_dwordx2 v[96:97], v246, s[28:31], s70 offen offset:0 sc1 nt
    v_cvt_f32_i32 v123, v123
    v_mfma_i32_16x16x64_i8 v[196:199], a[76:79], v[28:31], v[196:199]
    ds_read_b128 v[56:59], v244 offset:12544
    s_waitcnt lgkmcnt(3)
    v_mfma_i32_16x16x64_i8 v[184:187], a[16:19], v[32:35], v[184:187]
    v_cvt_f32_i32 v127, v127
    v_fma_f32 v123, v123, v64, v66
    v_mfma_i32_16x16x64_i8 v[184:187], a[20:23], v[36:39], v[184:187]
    ds_read_b128 v[60:63], v244 offset:14592
    v_fma_f32 v127, v127, v65, v67
    v_mfma_i32_16x16x64_i8 v[192:195], a[80:83], v[32:35], v[192:195]
    v_cvt_pk_bf16_f32 v98, v123, v127
    v_cvt_f32_i32 v139, v139
    v_mfma_i32_16x16x64_i8 v[192:195], a[84:87], v[36:39], v[192:195]
    s_waitcnt vmcnt(13)
    s_barrier
    ds_read_b128 v[16:19], v244 offset:32768
    v_mfma_i32_16x16x64_i8 v[188:191], a[16:19], v[40:43], v[188:191]
    buffer_load_dwordx4 v3, s[36:39], s44 offen offset:2048 sc1 lds
    v_mfma_i32_16x16x64_i8 v[188:191], a[20:23], v[44:47], v[188:191]
    ds_read_b128 v[20:23], v244 offset:34816
    v_cvt_f32_i32 v143, v143
    v_mfma_i32_16x16x64_i8 v[196:199], a[80:83], v[40:43], v[196:199]
    v_fma_f32 v139, v139, v68, v70
    v_fma_f32 v143, v143, v69, v71
    v_mfma_i32_16x16x64_i8 v[196:199], a[84:87], v[44:47], v[196:199]
    ds_read_b128 v[24:27], v244 offset:33024
    s_waitcnt lgkmcnt(3)
    v_mfma_i32_16x16x64_i8 v[184:187], a[24:27], v[48:51], v[184:187]
    v_cvt_pk_bf16_f32 v99, v139, v143
    v_cvt_f32_i32 v128, v128
    v_mfma_i32_16x16x64_i8 v[184:187], a[28:31], v[52:55], v[184:187]
    ds_read_b128 v[28:31], v244 offset:35072
    v_cvt_f32_i32 v132, v132
    v_mfma_i32_16x16x64_i8 v[192:195], a[88:91], v[48:51], v[192:195]
    buffer_load_dwordx4 v3, s[36:39], s44 offen offset:3072 sc1 lds
    v_mfma_i32_16x16x64_i8 v[192:195], a[92:95], v[52:55], v[192:195]
    ds_read_b128 v[32:35], v244 offset:36864
    s_add_u32 s44, s61, 212992
    v_mfma_i32_16x16x64_i8 v[188:191], a[24:27], v[56:59], v[188:191]
    s_add_u32 m0, s61, 49152
    v_fma_f32 v128, v128, v64, v66
    v_mfma_i32_16x16x64_i8 v[188:191], a[28:31], v[60:63], v[188:191]
    ds_read_b128 v[36:39], v244 offset:38912
    v_fma_f32 v132, v132, v65, v67
    v_mfma_i32_16x16x64_i8 v[196:199], a[88:91], v[56:59], v[196:199]
    buffer_store_dwordx2 v[98:99], v246, s[28:31], s71 offen offset:0 sc1 nt
    v_cvt_pk_bf16_f32 v100, v128, v132
    v_mfma_i32_16x16x64_i8 v[196:199], a[92:95], v[60:63], v[196:199]
    ds_read_b128 v[40:43], v244 offset:37120
    s_waitcnt lgkmcnt(3)
    v_mfma_i32_16x16x64_i8 v[184:187], a[32:35], v[16:19], v[184:187]
    buffer_load_dwordx4 v3, s[36:39], s44 offen sc1 lds
    v_mfma_i32_16x16x64_i8 v[184:187], a[36:39], v[20:23], v[184:187]
    ds_read_b128 v[44:47], v244 offset:39168
    v_cvt_f32_i32 v144, v144
    v_mfma_i32_16x16x64_i8 v[192:195], a[96:99], v[16:19], v[192:195]
    v_cvt_f32_i32 v148, v148
    v_fma_f32 v144, v144, v68, v70
    v_mfma_i32_16x16x64_i8 v[192:195], a[100:103], v[20:23], v[192:195]
    ds_read_b128 v[48:51], v244 offset:40960
    v_fma_f32 v148, v148, v69, v71
    v_mfma_i32_16x16x64_i8 v[188:191], a[32:35], v[24:27], v[188:191]
    v_cvt_pk_bf16_f32 v101, v144, v148
    v_cvt_f32_i32 v129, v129
    v_mfma_i32_16x16x64_i8 v[188:191], a[36:39], v[28:31], v[188:191]
    ds_read_b128 v[52:55], v244 offset:43008
    v_cvt_f32_i32 v133, v133
    v_mfma_i32_16x16x64_i8 v[196:199], a[96:99], v[24:27], v[196:199]
    buffer_store_dwordx2 v[100:101], v246, s[28:31], s72 offen offset:0 sc1 nt
    v_fma_f32 v129, v129, v64, v66
    v_mfma_i32_16x16x64_i8 v[196:199], a[100:103], v[28:31], v[196:199]
    ds_read_b128 v[56:59], v244 offset:41216
    s_waitcnt lgkmcnt(3)
    v_mfma_i32_16x16x64_i8 v[184:187], a[40:43], v[32:35], v[184:187]
    v_fma_f32 v133, v133, v65, v67
    v_cvt_pk_bf16_f32 v102, v129, v133
    v_mfma_i32_16x16x64_i8 v[184:187], a[44:47], v[36:39], v[184:187]
    ds_read_b128 v[60:63], v244 offset:43264
    v_cvt_f32_i32 v145, v145
    v_mfma_i32_16x16x64_i8 v[192:195], a[104:107], v[32:35], v[192:195]
    v_cvt_f32_i32 v149, v149
    v_fma_f32 v145, v145, v68, v70
    v_mfma_i32_16x16x64_i8 v[192:195], a[108:111], v[36:39], v[192:195]
    ds_read_b128 v[16:19], v244 offset:45056
    v_fma_f32 v149, v149, v69, v71
    v_mfma_i32_16x16x64_i8 v[188:191], a[40:43], v[40:43], v[188:191]
    v_cvt_pk_bf16_f32 v103, v145, v149
    v_cvt_f32_i32 v130, v130
    v_mfma_i32_16x16x64_i8 v[188:191], a[44:47], v[44:47], v[188:191]
    ds_read_b128 v[20:23], v244 offset:47104
    v_cvt_f32_i32 v134, v134
    v_mfma_i32_16x16x64_i8 v[196:199], a[104:107], v[40:43], v[196:199]
    buffer_store_dwordx2 v[102:103], v246, s[28:31], s73 offen offset:0 sc1 nt
    v_fma_f32 v130, v130, v64, v66
    v_mfma_i32_16x16x64_i8 v[196:199], a[108:111], v[44:47], v[196:199]
    ds_read_b128 v[24:27], v244 offset:45312
    s_waitcnt lgkmcnt(3)
    v_mfma_i32_16x16x64_i8 v[184:187], a[48:51], v[48:51], v[184:187]
    v_fma_f32 v134, v134, v65, v67
    v_cvt_pk_bf16_f32 v104, v130, v134
    v_mfma_i32_16x16x64_i8 v[184:187], a[52:55], v[52:55], v[184:187]
    ds_read_b128 v[28:31], v244 offset:47360
    v_cvt_f32_i32 v146, v146
    v_mfma_i32_16x16x64_i8 v[192:195], a[112:115], v[48:51], v[192:195]
    v_cvt_f32_i32 v150, v150
    v_fma_f32 v146, v146, v68, v70
    v_mfma_i32_16x16x64_i8 v[192:195], a[116:119], v[52:55], v[192:195]
    s_waitcnt vmcnt(15)
    s_barrier
    ds_read_b128 v[32:35], v245 offset:0
    v_mfma_i32_16x16x64_i8 v[188:191], a[48:51], v[56:59], v[188:191]
    buffer_load_dwordx4 v3, s[36:39], s44 offen offset:1024 sc1 lds
    v_mfma_i32_16x16x64_i8 v[188:191], a[52:55], v[60:63], v[188:191]
    ds_read_b128 v[36:39], v245 offset:2048
    v_fma_f32 v150, v150, v69, v71
    v_mfma_i32_16x16x64_i8 v[196:199], a[112:115], v[56:59], v[196:199]
    v_cvt_pk_bf16_f32 v105, v146, v150
    v_cvt_f32_i32 v131, v131
    v_mfma_i32_16x16x64_i8 v[196:199], a[116:119], v[60:63], v[196:199]
    ds_read_b128 v[40:43], v245 offset:256
    s_waitcnt lgkmcnt(3)
    v_mfma_i32_16x16x64_i8 v[184:187], a[56:59], v[16:19], v[184:187]
    buffer_store_dwordx2 v[104:105], v246, s[28:31], s74 offen offset:0 sc1 nt
    v_cvt_f32_i32 v135, v135
    v_mfma_i32_16x16x64_i8 v[184:187], a[60:63], v[20:23], v[184:187]
    ds_read_b128 v[44:47], v245 offset:2304
    v_fma_f32 v131, v131, v64, v66
    v_mfma_i32_16x16x64_i8 v[192:195], a[120:123], v[16:19], v[192:195]
    buffer_load_dwordx4 v3, s[36:39], s44 offen offset:2048 sc1 lds
    v_mfma_i32_16x16x64_i8 v[192:195], a[124:127], v[20:23], v[192:195]
    ds_read_b128 v[48:51], v245 offset:4096
    v_fma_f32 v135, v135, v65, v67
    v_mfma_i32_16x16x64_i8 v[188:191], a[56:59], v[24:27], v[188:191]
    v_cvt_pk_bf16_f32 v106, v131, v135
    v_cvt_f32_i32 v147, v147
    v_mfma_i32_16x16x64_i8 v[188:191], a[60:63], v[28:31], v[188:191]
    ds_read_b128 v[52:55], v245 offset:6144
    v_cvt_f32_i32 v151, v151
    v_mfma_i32_16x16x64_i8 v[196:199], a[120:123], v[24:27], v[196:199]
    v_fma_f32 v147, v147, v68, v70
    v_fma_f32 v151, v151, v69, v71
    v_mfma_i32_16x16x64_i8 v[196:199], a[124:127], v[28:31], v[196:199]
    ds_read_b128 v[56:59], v245 offset:4352
    s_waitcnt lgkmcnt(3)
    v_mfma_i32_16x16x64_i8 v[200:203], a[0:3], v[32:35], 0
    buffer_load_dwordx4 v3, s[36:39], s44 offen offset:3072 sc1 lds
    v_mfma_i32_16x16x64_i8 v[200:203], a[4:7], v[36:39], v[200:203]
    ds_read_b128 v[60:63], v245 offset:6400
    v_cvt_pk_bf16_f32 v107, v147, v151
    v_mfma_i32_16x16x64_i8 v[208:211], a[64:67], v[32:35], 0
    buffer_store_dwordx2 v[106:107], v246, s[28:31], s75 offen offset:0 sc1 nt
    v_cvt_f32_i32 v152, v152
    v_mfma_i32_16x16x64_i8 v[208:211], a[68:71], v[36:39], v[208:211]
    ds_read_b128 v[16:19], v245 offset:8192
    v_cvt_f32_i32 v156, v156
    v_mfma_i32_16x16x64_i8 v[204:207], a[0:3], v[40:43], 0
    v_fma_f32 v152, v152, v72, v74
    v_fma_f32 v156, v156, v73, v75
    v_mfma_i32_16x16x64_i8 v[204:207], a[4:7], v[44:47], v[204:207]
    ds_read_b128 v[20:23], v245 offset:10240
    v_cvt_pk_bf16_f32 v92, v152, v156
    v_mfma_i32_16x16x64_i8 v[212:215], a[64:67], v[40:43], 0
    v_cvt_f32_i32 v168, v168
    v_cvt_f32_i32 v172, v172
    v_mfma_i32_16x16x64_i8 v[212:215], a[68:71], v[44:47], v[212:215]
    ds_read_b128 v[24:27], v245 offset:8448
    s_waitcnt lgkmcnt(3)
    v_mfma_i32_16x16x64_i8 v[200:203], a[8:11], v[48:51], v[200:203]
    v_fma_f32 v168, v168, v76, v78
    v_fma_f32 v172, v172, v77, v79
    v_mfma_i32_16x16x64_i8 v[200:203], a[12:15], v[52:55], v[200:203]
    ds_read_b128 v[28:31], v245 offset:10496
    v_cvt_pk_bf16_f32 v93, v168, v172
    v_mfma_i32_16x16x64_i8 v[208:211], a[72:75], v[48:51], v[208:211]
    buffer_store_dwordx2 v[92:93], v246, s[28:31], s68 offen offset:128 sc1 nt
    v_cvt_f32_i32 v153, v153
    v_mfma_i32_16x16x64_i8 v[208:211], a[76:79], v[52:55], v[208:211]
    ds_read_b128 v[32:35], v245 offset:12288
    v_cvt_f32_i32 v157, v157
    v_mfma_i32_16x16x64_i8 v[204:207], a[8:11], v[56:59], v[204:207]
    v_fma_f32 v153, v153, v72, v74
    v_fma_f32 v157, v157, v73, v75
    v_mfma_i32_16x16x64_i8 v[204:207], a[12:15], v[60:63], v[204:207]
    ds_read_b128 v[36:39], v245 offset:14336
    v_cvt_pk_bf16_f32 v94, v153, v157
    v_mfma_i32_16x16x64_i8 v[212:215], a[72:75], v[56:59], v[212:215]
    v_cvt_f32_i32 v169, v169
    v_cvt_f32_i32 v173, v173
    v_mfma_i32_16x16x64_i8 v[212:215], a[76:79], v[60:63], v[212:215]
    ds_read_b128 v[40:43], v245 offset:12544
    s_waitcnt lgkmcnt(3)
    v_mfma_i32_16x16x64_i8 v[200:203], a[16:19], v[16:19], v[200:203]
    v_fma_f32 v169, v169, v76, v78
    v_fma_f32 v173, v173, v77, v79
    v_mfma_i32_16x16x64_i8 v[200:203], a[20:23], v[20:23], v[200:203]
    ds_read_b128 v[44:47], v245 offset:14592
    v_cvt_pk_bf16_f32 v95, v169, v173
    v_mfma_i32_16x16x64_i8 v[208:211], a[80:83], v[16:19], v[208:211]
    buffer_store_dwordx2 v[94:95], v246, s[28:31], s69 offen offset:128 sc1 nt
    v_cvt_f32_i32 v154, v154
    v_mfma_i32_16x16x64_i8 v[208:211], a[84:87], v[20:23], v[208:211]
    s_waitcnt vmcnt(18)
    s_barrier
    ds_read_b128 v[48:51], v245 offset:32768
    v_mfma_i32_16x16x64_i8 v[204:207], a[16:19], v[24:27], v[204:207]
    v_cvt_f32_i32 v158, v158
    v_fma_f32 v154, v154, v72, v74
    v_mfma_i32_16x16x64_i8 v[204:207], a[20:23], v[28:31], v[204:207]
    ds_read_b128 v[52:55], v245 offset:34816
    v_fma_f32 v158, v158, v73, v75
    v_mfma_i32_16x16x64_i8 v[212:215], a[80:83], v[24:27], v[212:215]
    v_cvt_pk_bf16_f32 v96, v154, v158
    v_cvt_f32_i32 v170, v170
    v_mfma_i32_16x16x64_i8 v[212:215], a[84:87], v[28:31], v[212:215]
    ds_read_b128 v[56:59], v245 offset:33024
ISL2:
    s_cbranch_vccnz WARMRET
    s_waitcnt lgkmcnt(3)
    v_mfma_i32_16x16x64_i8 v[200:203], a[24:27], v[32:35], v[200:203]
    v_cvt_f32_i32 v174, v174
    v_fma_f32 v170, v170, v76, v78
    v_mfma_i32_16x16x64_i8 v[200:203], a[28:31], v[36:39], v[200:203]
    ds_read_b128 v[60:63], v245 offset:35072
    v_fma_f32 v174, v174, v77, v79
    v_mfma_i32_16x16x64_i8 v[208:211], a[88:91], v[32:35], v[208:211]
    v_cvt_pk_bf16_f32 v97, v170, v174
    v_cvt_f32_i32 v155, v155
    v_mfma_i32_16x16x64_i8 v[208:211], a[92:95], v[36:39], v[208:211]
    ds_read_b128 v[16:19], v245 offset:36864
    v_cvt_f32_i32 v159, v159
    v_mfma_i32_16x16x64_i8 v[204:207], a[24:27], v[40:43], v[204:207]
    buffer_store_dwordx2 v[96:97], v246, s[28:31], s70 offen offset:128 sc1 nt
    v_fma_f32 v155, v155, v72, v74
    v_mfma_i32_16x16x64_i8 v[204:207], a[28:31], v[44:47], v[204:207]
    ds_read_b128 v[20:23], v245 offset:38912
    v_fma_f32 v159, v159, v73, v75
    v_mfma_i32_16x16x64_i8 v[212:215], a[88:91], v[40:43], v[212:215]
    v_cvt_pk_bf16_f32 v98, v155, v159
    v_cvt_f32_i32 v171, v171
    v_mfma_i32_16x16x64_i8 v[212:215], a[92:95], v[44:47], v[212:215]
    ds_read_b128 v[24:27], v245 offset:37120
    s_waitcnt lgkmcnt(3)
    v_mfma_i32_16x16x64_i8 v[200:203], a[32:35], v[48:51], v[200:203]
    v_cvt_f32_i32 v175, v175
    v_fma_f32 v171, v171, v76, v78
    v_mfma_i32_16x16x64_i8 v[200:203], a[36:39], v[52:55], v[200:203]
    ds_read_b128 v[28:31], v245 offset:39168
    v_fma_f32 v175, v175, v77, v79
    v_mfma_i32_16x16x64_i8 v[208:211], a[96:99], v[48:51], v[208:211]
    v_cvt_pk_bf16_f32 v99, v171, v175
    v_cvt_f32_i32 v160, v160
    v_mfma_i32_16x16x64_i8 v[208:211], a[100:103], v[52:55], v[208:211]
    ds_read_b128 v[32:35], v245 offset:40960
    v_cvt_f32_i32 v164, v164
    v_mfma_i32_16x16x64_i8 v[204:207], a[32:35], v[56:59], v[204:207]
    buffer_store_dwordx2 v[98:99], v246, s[28:31], s71 offen offset:128 sc1 nt
    v_fma_f32 v160, v160, v72, v74
    v_mfma_i32_16x16x64_i8 v[204:207], a[36:39], v[60:63], v[204:207]
    ds_read_b128 v[36:39], v245 offset:43008
    v_fma_f32 v164, v164, v73, v75
    v_mfma_i32_16x16x64_i8 v[212:215], a[96:99], v[56:59], v[212:215]
    v_cvt_pk_bf16_f32 v100, v160, v164
    v_cvt_f32_i32 v176, v176
    v_mfma_i32_16x16x64_i8 v[212:215], a[100:103], v[60:63], v[212:215]
    ds_read_b128 v[40:43], v245 offset:41216
    s_waitcnt lgkmcnt(3)
    v_mfma_i32_16x16x64_i8 v[200:203], a[40:43], v[16:19], v[200:203]
    v_cvt_f32_i32 v180, v180
    v_fma_f32 v176, v176, v76, v78
    v_mfma_i32_16x16x64_i8 v[200:203], a[44:47], v[20:23], v[200:203]
    ds_read_b128 v[44:47], v245 offset:43264
    v_fma_f32 v180, v180, v77, v79
    v_mfma_i32_16x16x64_i8 v[208:211], a[104:107], v[16:19], v[208:211]
    v_cvt_pk_bf16_f32 v101, v176, v180
    v_cvt_f32_i32 v161, v161
    v_mfma_i32_16x16x64_i8 v[208:211], a[108:111], v[20:23], v[208:211]
    ds_read_b128 v[48:51], v245 offset:45056
    v_cvt_f32_i32 v165, v165
    v_mfma_i32_16x16x64_i8 v[204:207], a[40:43], v[24:27], v[204:207]
    buffer_store_dwordx2 v[100:101], v246, s[28:31], s72 offen offset:128 sc1 nt
    v_fma_f32 v161, v161, v72, v74
    v_mfma_i32_16x16x64_i8 v[204:207], a[44:47], v[28:31], v[204:207]
    ds_read_b128 v[52:55], v245 offset:47104
    v_fma_f32 v165, v165, v73, v75
    v_mfma_i32_16x16x64_i8 v[212:215], a[104:107], v[24:27], v[212:215]
    v_cvt_pk_bf16_f32 v102, v161, v165
    v_cvt_f32_i32 v177, v177
    v_mfma_i32_16x16x64_i8 v[212:215], a[108:111], v[28:31], v[212:215]
    ds_read_b128 v[56:59], v245 offset:45312
    s_waitcnt lgkmcnt(3)
    v_mfma_i32_16x16x64_i8 v[200:203], a[48:51], v[32:35], v[200:203]
    v_cvt_f32_i32 v181, v181
    v_fma_f32 v177, v177, v76, v78
    v_mfma_i32_16x16x64_i8 v[200:203], a[52:55], v[36:39], v[200:203]
    ds_read_b128 v[60:63], v245 offset:47360
    v_fma_f32 v181, v181, v77, v79
    v_mfma_i32_16x16x64_i8 v[208:211], a[112:115], v[32:35], v[208:211]
    v_cvt_pk_bf16_f32 v103, v177, v181
    v_cvt_f32_i32 v162, v162
    v_mfma_i32_16x16x64_i8 v[208:211], a[116:119], v[36:39], v[208:211]
    s_waitcnt vmcnt(14)
    s_barrier
    ds_read_b128 v[16:19], v244 offset:16384
    v_mfma_i32_16x16x64_i8 v[204:207], a[48:51], v[40:43], v[204:207]
    buffer_store_dwordx2 v[102:103], v246, s[28:31], s73 offen offset:128 sc1 nt
    v_cvt_f32_i32 v166, v166
    v_mfma_i32_16x16x64_i8 v[204:207], a[52:55], v[44:47], v[204:207]
    ds_read_b128 v[20:23], v244 offset:18432
    v_fma_f32 v162, v162, v72, v74
    v_mfma_i32_16x16x64_i8 v[212:215], a[112:115], v[40:43], v[212:215]
    v_fma_f32 v166, v166, v73, v75
    v_cvt_pk_bf16_f32 v104, v162, v166
    v_mfma_i32_16x16x64_i8 v[212:215], a[116:119], v[44:47], v[212:215]
    ds_read_b128 v[24:27], v244 offset:16640
    s_waitcnt lgkmcnt(3)
    v_mfma_i32_16x16x64_i8 v[200:203], a[56:59], v[48:51], v[200:203]
    v_cvt_f32_i32 v178, v178
    v_cvt_f32_i32 v182, v182
    v_mfma_i32_16x16x64_i8 v[200:203], a[60:63], v[52:55], v[200:203]
    ds_read_b128 v[28:31], v244 offset:18688
    v_fma_f32 v178, v178, v76, v78
    v_mfma_i32_16x16x64_i8 v[208:211], a[120:123], v[48:51], v[208:211]
    v_fma_f32 v182, v182, v77, v79
    v_cvt_pk_bf16_f32 v105, v178, v182
    v_mfma_i32_16x16x64_i8 v[208:211], a[124:127], v[52:55], v[208:211]
    ds_read_b128 v[32:35], v244 offset:20480
    v_cvt_f32_i32 v163, v163
    v_mfma_i32_16x16x64_i8 v[204:207], a[56:59], v[56:59], v[204:207]
    buffer_store_dwordx2 v[104:105], v246, s[28:31], s74 offen offset:128 sc1 nt
    v_cvt_f32_i32 v167, v167
    v_mfma_i32_16x16x64_i8 v[204:207], a[60:63], v[60:63], v[204:207]
    ds_read_b128 v[36:39], v244 offset:22528
    v_fma_f32 v163, v163, v72, v74
    v_mfma_i32_16x16x64_i8 v[212:215], a[120:123], v[56:59], v[212:215]
    v_fma_f32 v167, v167, v73, v75
    v_cvt_pk_bf16_f32 v106, v163, v167
    v_mfma_i32_16x16x64_i8 v[212:215], a[124:127], v[60:63], v[212:215]
    ds_read_b128 v[40:43], v244 offset:20736
    s_waitcnt lgkmcnt(3)
    v_mfma_i32_16x16x64_i8 v[216:219], a[0:3], v[16:19], 0
    v_cvt_f32_i32 v179, v179
    v_cvt_f32_i32 v183, v183
    v_mfma_i32_16x16x64_i8 v[216:219], a[4:7], v[20:23], v[216:219]
    ds_read_b128 v[44:47], v244 offset:22784
    v_fma_f32 v179, v179, v76, v78
    v_mfma_i32_16x16x64_i8 v[224:227], a[64:67], v[16:19], 0
    v_fma_f32 v183, v183, v77, v79
    v_cvt_pk_bf16_f32 v107, v179, v183
    v_mfma_i32_16x16x64_i8 v[224:227], a[68:71], v[20:23], v[224:227]
    ds_read_b128 v[48:51], v244 offset:24576
    v_cvt_f32_i32 v184, v184
    v_mfma_i32_16x16x64_i8 v[220:223], a[0:3], v[24:27], 0
    buffer_store_dwordx2 v[106:107], v246, s[28:31], s75 offen offset:128 sc1 nt
    v_cvt_f32_i32 v188, v188
    v_mfma_i32_16x16x64_i8 v[220:223], a[4:7], v[28:31], v[220:223]
    ds_read_b128 v[52:55], v244 offset:26624
    v_fma_f32 v184, v184, v80, v82
    v_mfma_i32_16x16x64_i8 v[228:231], a[64:67], v[24:27], 0
    v_fma_f32 v188, v188, v81, v83
    v_cvt_pk_bf16_f32 v92, v184, v188
    v_mfma_i32_16x16x64_i8 v[228:231], a[68:71], v[28:31], v[228:231]
    ds_read_b128 v[56:59], v244 offset:24832
    s_waitcnt lgkmcnt(3)
    v_mfma_i32_16x16x64_i8 v[216:219], a[8:11], v[32:35], v[216:219]
    v_cvt_f32_i32 v200, v200
    v_cvt_f32_i32 v204, v204
    v_mfma_i32_16x16x64_i8 v[216:219], a[12:15], v[36:39], v[216:219]
    ds_read_b128 v[60:63], v244 offset:26880
    v_fma_f32 v200, v200, v84, v86
    v_mfma_i32_16x16x64_i8 v[224:227], a[72:75], v[32:35], v[224:227]
    v_fma_f32 v204, v204, v85, v87
    v_cvt_pk_bf16_f32 v93, v200, v204
    v_mfma_i32_16x16x64_i8 v[224:227], a[76:79], v[36:39], v[224:227]
    ds_read_b128 v[16:19], v244 offset:28672
    v_cvt_f32_i32 v185, v185
    v_mfma_i32_16x16x64_i8 v[220:223], a[8:11], v[40:43], v[220:223]
    buffer_store_dwordx2 v[92:93], v246, s[28:31], s68 offen offset:256 sc1 nt
    v_cvt_f32_i32 v189, v189
    v_mfma_i32_16x16x64_i8 v[220:223], a[12:15], v[44:47], v[220:223]
    ds_read_b128 v[20:23], v244 offset:30720
    v_fma_f32 v185, v185, v80, v82
    v_mfma_i32_16x16x64_i8 v[228:231], a[72:75], v[40:43], v[228:231]
    v_fma_f32 v189, v189, v81, v83
    v_cvt_pk_bf16_f32 v94, v185, v189
    v_mfma_i32_16x16x64_i8 v[228:231], a[76:79], v[44:47], v[228:231]
    ds_read_b128 v[24:27], v244 offset:28928
    s_waitcnt lgkmcnt(3)
    v_mfma_i32_16x16x64_i8 v[216:219], a[16:19], v[48:51], v[216:219]
    v_cvt_f32_i32 v201, v201
    v_cvt_f32_i32 v205, v205
    v_mfma_i32_16x16x64_i8 v[216:219], a[20:23], v[52:55], v[216:219]
    ds_read_b128 v[28:31], v244 offset:30976
    v_fma_f32 v201, v201, v84, v86
    v_mfma_i32_16x16x64_i8 v[224:227], a[80:83], v[48:51], v[224:227]
    v_fma_f32 v205, v205, v85, v87
    v_cvt_pk_bf16_f32 v95, v201, v205
    v_mfma_i32_16x16x64_i8 v[224:227], a[84:87], v[52:55], v[224:227]
    s_waitcnt vmcnt(10)
    s_barrier
    ds_read_b128 v[32:35], v244 offset:49152
    v_mfma_i32_16x16x64_i8 v[220:223], a[16:19], v[56:59], v[220:223]
    buffer_store_dwordx2 v[94:95], v246, s[28:31], s69 offen offset:256 sc1 nt
    v_cvt_f32_i32 v186, v186
    v_mfma_i32_16x16x64_i8 v[220:223], a[20:23], v[60:63], v[220:223]
    ds_read_b128 v[36:39], v244 offset:51200
    v_cvt_f32_i32 v190, v190
    v_mfma_i32_16x16x64_i8 v[228:231], a[80:83], v[56:59], v[228:231]
    v_fma_f32 v186, v186, v80, v82
    v_fma_f32 v190, v190, v81, v83
    v_mfma_i32_16x16x64_i8 v[228:231], a[84:87], v[60:63], v[228:231]
    ds_read_b128 v[40:43], v244 offset:49408
    s_waitcnt lgkmcnt(3)
    v_mfma_i32_16x16x64_i8 v[216:219], a[24:27], v[16:19], v[216:219]
    v_cvt_pk_bf16_f32 v96, v186, v190
    v_cvt_f32_i32 v202, v202
    v_mfma_i32_16x16x64_i8 v[216:219], a[28:31], v[20:23], v[216:219]
    ds_read_b128 v[44:47], v244 offset:51456
    v_cvt_f32_i32 v206, v206
    v_mfma_i32_16x16x64_i8 v[224:227], a[88:91], v[16:19], v[224:227]
    v_fma_f32 v202, v202, v84, v86
    v_fma_f32 v206, v206, v85, v87
    v_mfma_i32_16x16x64_i8 v[224:227], a[92:95], v[20:23], v[224:227]
    ds_read_b128 v[48:51], v244 offset:53248
    v_cvt_pk_bf16_f32 v97, v202, v206
    v_mfma_i32_16x16x64_i8 v[220:223], a[24:27], v[24:27], v[220:223]
    buffer_store_dwordx2 v[96:97], v246, s[28:31], s70 offen offset:256 sc1 nt
    v_cvt_f32_i32 v187, v187
    v_mfma_i32_16x16x64_i8 v[220:223], a[28:31], v[28:31], v[220:223]
    ds_read_b128 v[52:55], v244 offset:55296
    v_cvt_f32_i32 v191, v191
    v_mfma_i32_16x16x64_i8 v[228:231], a[88:91], v[24:27], v[228:231]
    v_fma_f32 v187, v187, v80, v82
    v_fma_f32 v191, v191, v81, v83
    v_mfma_i32_16x16x64_i8 v[228:231], a[92:95], v[28:31], v[228:231]
    ds_read_b128 v[56:59], v244 offset:53504
    s_waitcnt lgkmcnt(3)
    v_mfma_i32_16x16x64_i8 v[216:219], a[32:35], v[32:35], v[216:219]
    v_cvt_pk_bf16_f32 v98, v187, v191
    v_cvt_f32_i32 v203, v203
    v_mfma_i32_16x16x64_i8 v[216:219], a[36:39], v[36:39], v[216:219]
    ds_read_b128 v[60:63], v244 offset:55552
    v_cvt_f32_i32 v207, v207
    v_mfma_i32_16x16x64_i8 v[224:227], a[96:99], v[32:35], v[224:227]
    v_fma_f32 v203, v203, v84, v86
    v_fma_f32 v207, v207, v85, v87
    v_mfma_i32_16x16x64_i8 v[224:227], a[100:103], v[36:39], v[224:227]
    ds_read_b128 v[16:19], v244 offset:57344
    v_cvt_pk_bf16_f32 v99, v203, v207
    v_mfma_i32_16x16x64_i8 v[220:223], a[32:35], v[40:43], v[220:223]
    buffer_store_dwordx2 v[98:99], v246, s[28:31], s71 offen offset:256 sc1 nt
    v_cvt_f32_i32 v192, v192
    v_mfma_i32_16x16x64_i8 v[220:223], a[36:39], v[44:47], v[220:223]
    ds_read_b128 v[20:23], v244 offset:59392
    v_cvt_f32_i32 v196, v196
    v_mfma_i32_16x16x64_i8 v[228:231], a[96:99], v[40:43], v[228:231]
    v_fma_f32 v192, v192, v80, v82
    v_fma_f32 v196, v196, v81, v83
    v_mfma_i32_16x16x64_i8 v[228:231], a[100:103], v[44:47], v[228:231]
    ds_read_b128 v[24:27], v244 offset:57600
    s_waitcnt lgkmcnt(3)
    v_mfma_i32_16x16x64_i8 v[216:219], a[40:43], v[48:51], v[216:219]
    v_cvt_pk_bf16_f32 v100, v192, v196
    v_cvt_f32_i32 v208, v208
    v_mfma_i32_16x16x64_i8 v[216:219], a[44:47], v[52:55], v[216:219]
    ds_read_b128 v[28:31], v244 offset:59648
    v_cvt_f32_i32 v212, v212
    v_mfma_i32_16x16x64_i8 v[224:227], a[104:107], v[48:51], v[224:227]
    v_fma_f32 v208, v208, v84, v86
    v_fma_f32 v212, v212, v85, v87
    v_mfma_i32_16x16x64_i8 v[224:227], a[108:111], v[52:55], v[224:227]
    ds_read_b128 v[32:35], v244 offset:61440
    v_cvt_pk_bf16_f32 v101, v208, v212
    v_mfma_i32_16x16x64_i8 v[220:223], a[40:43], v[56:59], v[220:223]
    buffer_store_dwordx2 v[100:101], v246, s[28:31], s72 offen offset:256 sc1 nt
    v_cvt_f32_i32 v193, v193
    v_mfma_i32_16x16x64_i8 v[220:223], a[44:47], v[60:63], v[220:223]
    ds_read_b128 v[36:39], v244 offset:63488
    v_cvt_f32_i32 v197, v197
    v_mfma_i32_16x16x64_i8 v[228:231], a[104:107], v[56:59], v[228:231]
    v_fma_f32 v193, v193, v80, v82
    v_fma_f32 v197, v197, v81, v83
    v_mfma_i32_16x16x64_i8 v[228:231], a[108:111], v[60:63], v[228:231]
    ds_read_b128 v[40:43], v244 offset:61696
    s_waitcnt lgkmcnt(3)
    v_mfma_i32_16x16x64_i8 v[216:219], a[48:51], v[16:19], v[216:219]
    v_cvt_pk_bf16_f32 v102, v193, v197
    v_cvt_f32_i32 v209, v209
    v_mfma_i32_16x16x64_i8 v[216:219], a[52:55], v[20:23], v[216:219]
    ds_read_b128 v[44:47], v244 offset:63744
    v_cvt_f32_i32 v213, v213
    v_mfma_i32_16x16x64_i8 v[224:227], a[112:115], v[16:19], v[224:227]
    v_fma_f32 v209, v209, v84, v86
    v_fma_f32 v213, v213, v85, v87
    v_mfma_i32_16x16x64_i8 v[224:227], a[116:119], v[20:23], v[224:227]
    v_cvt_pk_bf16_f32 v103, v209, v213
    v_cvt_f32_i32 v194, v194
    v_mfma_i32_16x16x64_i8 v[220:223], a[48:51], v[24:27], v[220:223]
    buffer_store_dwordx2 v[102:103], v246, s[28:31], s73 offen offset:256 sc1 nt
    v_cvt_f32_i32 v198, v198
    v_mfma_i32_16x16x64_i8 v[220:223], a[52:55], v[28:31], v[220:223]
    s_waitcnt lgkmcnt(0)
    v_fma_f32 v194, v194, v80, v82
    v_mfma_i32_16x16x64_i8 v[216:219], a[56:59], v[32:35], v[216:219]
    v_fma_f32 v198, v198, v81, v83
    v_cvt_pk_bf16_f32 v104, v194, v198
    v_mfma_i32_16x16x64_i8 v[216:219], a[60:63], v[36:39], v[216:219]
    v_cvt_f32_i32 v210, v210
    v_cvt_f32_i32 v214, v214
    v_mfma_i32_16x16x64_i8 v[220:223], a[56:59], v[40:43], v[220:223]
    v_fma_f32 v210, v210, v84, v86
    v_fma_f32 v214, v214, v85, v87
    v_mfma_i32_16x16x64_i8 v[220:223], a[60:63], v[44:47], v[220:223]
    v_cvt_pk_bf16_f32 v105, v210, v214
    buffer_store_dwordx2 v[104:105], v246, s[28:31], s74 offen offset:256 sc1 nt
    v_cvt_f32_i32 v195, v195
    v_cvt_f32_i32 v199, v199
    v_fma_f32 v195, v195, v80, v82
    v_fma_f32 v199, v199, v81, v83
    v_cvt_pk_bf16_f32 v106, v195, v199
    v_cvt_f32_i32 v211, v211
    v_cvt_f32_i32 v215, v215
    v_fma_f32 v211, v211, v84, v86
    v_fma_f32 v215, v215, v85, v87
    v_cvt_pk_bf16_f32 v107, v211, v215
    buffer_store_dwordx2 v[106:107], v246, s[28:31], s75 offen offset:256 sc1 nt
    v_mfma_i32_16x16x64_i8 v[228:231], a[112:115], v[24:27], v[228:231]
    v_cvt_f32_i32 v120, v216
    v_cvt_f32_i32 v121, v220
    v_mfma_i32_16x16x64_i8 v[228:231], a[116:119], v[28:31], v[228:231]
    v_cvt_f32_i32 v122, v217
    v_cvt_f32_i32 v123, v221
    v_mfma_i32_16x16x64_i8 v[224:227], a[120:123], v[32:35], v[224:227]
    v_cvt_f32_i32 v124, v218
    v_cvt_f32_i32 v125, v222
    v_mfma_i32_16x16x64_i8 v[224:227], a[124:127], v[36:39], v[224:227]
    v_cvt_f32_i32 v126, v219
    v_cvt_f32_i32 v127, v223
    v_mfma_i32_16x16x64_i8 v[228:231], a[120:123], v[40:43], v[228:231]
    s_nop 0
    s_nop 0
    v_mfma_i32_16x16x64_i8 v[228:231], a[124:127], v[44:47], v[228:231]
    v_pk_fma_f32 v[120:121], v[120:121], v[88:89], v[90:91]
    v_pk_fma_f32 v[122:123], v[122:123], v[88:89], v[90:91]
    v_pk_fma_f32 v[124:125], v[124:125], v[88:89], v[90:91]
    v_pk_fma_f32 v[126:127], v[126:127], v[88:89], v[90:91]
    v_cvt_pk_bf16_f32 v136, v120, v121
    v_cvt_pk_bf16_f32 v137, v122, v123
    v_cvt_pk_bf16_f32 v138, v124, v125
    v_cvt_pk_bf16_f32 v139, v126, v127
    buffer_store_dword v136, v247, s[28:31], s68 offen sc1 nt
    buffer_store_dword v137, v247, s[28:31], s69 offen sc1 nt
    buffer_store_dword v138, v247, s[28:31], s70 offen sc1 nt
    buffer_store_dword v139, v247, s[28:31], s71 offen sc1 nt
    v_cvt_f32_i32 v128, v224
    v_cvt_f32_i32 v129, v228
    v_cvt_f32_i32 v130, v225
    v_cvt_f32_i32 v131, v229
    v_cvt_f32_i32 v132, v226
    v_cvt_f32_i32 v133, v230
    v_cvt_f32_i32 v134, v227
    v_cvt_f32_i32 v135, v231
    v_pk_fma_f32 v[128:129], v[128:129], v[88:89], v[90:91]
    v_pk_fma_f32 v[130:131], v[130:131], v[88:89], v[90:91]
    v_pk_fma_f32 v[132:133], v[132:133], v[88:89], v[90:91]
    v_pk_fma_f32 v[134:135], v[134:135], v[88:89], v[90:91]
    v_cvt_pk_bf16_f32 v140, v128, v129
    v_cvt_pk_bf16_f32 v141, v130, v131
    v_cvt_pk_bf16_f32 v142, v132, v133
    v_cvt_pk_bf16_f32 v143, v134, v135
    buffer_store_dword v140, v247, s[28:31], s72 offen sc1 nt
    buffer_store_dword v141, v247, s[28:31], s73 offen sc1 nt
    buffer_store_dword v142, v247, s[28:31], s74 offen sc1 nt
    buffer_store_dword v143, v247, s[28:31], s75 offen sc1 nt
K_END:
    s_endpgm
PO0_SLOW:
    s_mov_b32 s55, 200000
PO0_RETRY:
    s_sleep 1
    s_mov_b32 s66, 7340032
    buffer_load_dword v236, v233, s[16:19], s66 offen sc1
    s_sub_u32 s55, s55, 1
    s_cbranch_scc1 PO0_OUT
    s_waitcnt vmcnt(0)
    v_cmp_ne_u32 vcc, s43, v236
    s_nop 0
    s_cmp_lg_u64 vcc, 0
    s_cbranch_scc1 PO0_RETRY
PO0_OUT:
    s_waitcnt vmcnt(0)
    s_mov_b64 vcc, 0
    s_branch PO0_OK
PO1_SLOW:
    s_mov_b32 s55, 200000
PO1_RETRY:
    s_sleep 1
    s_mov_b32 s66, 7479296
    buffer_load_dword v236, v233, s[16:19], s66 offen sc1
    s_sub_u32 s55, s55, 1
    s_cbranch_scc1 PO1_OUT
    s_waitcnt vmcnt(0)
    v_cmp_ne_u32 vcc, s43, v236
    s_nop 0
    s_cmp_lg_u64 vcc, 0
    s_cbranch_scc1 PO1_RETRY
PO1_OUT:
    s_waitcnt vmcnt(0)
    s_mov_b64 vcc, 0
    s_branch PO1_OK
PO2_SLOW:
    s_mov_b32 s55, 200000
PO2_RETRY:
    s_sleep 1
    buffer_load_dword v236, v233, s[16:19], s53 offen sc1
    s_sub_u32 s55, s55, 1
    s_cbranch_scc1 PO2_OUT
    s_waitcnt vmcnt(0)
    v_cmp_ne_u32 vcc, s43, v236
    s_nop 0
    s_cmp_lg_u64 vcc, 0
    s_cbranch_scc1 PO2_RETRY
PO2_OUT:
    s_waitcnt vmcnt(0)
    s_mov_b64 vcc, 0
    s_branch PO2_OK
PO3_SLOW:
    s_mov_b32 s55, 200000
PO3_RETRY:
    s_sleep 1
    buffer_load_dword v236, v233, s[16:19], s53 offen sc1
    s_sub_u32 s55, s55, 1
    s_cbranch_scc1 PO3_OUT
    s_waitcnt vmcnt(0)
    v_cmp_ne_u32 vcc, s43, v236
    s_nop 0
    s_cmp_lg_u64 vcc, 0
    s_cbranch_scc1 PO3_RETRY
PO3_OUT:
    s_waitcnt vmcnt(0)
    s_mov_b64 vcc, 0
    s_branch PO3_OK
PO4_SLOW:
    s_mov_b32 s55, 200000
PO4_RETRY:
    s_sleep 1
    buffer_load_dword v236, v234, s[16:19], s53 offen sc1
    s_sub_u32 s55, s55, 1
    s_cbranch_scc1 PO4_OUT
    s_waitcnt vmcnt(0)
    v_cmp_ne_u32 vcc, s43, v236
    s_nop 0
    s_cmp_lg_u64 vcc, 0
    s_cbranch_scc1 PO4_RETRY
PO4_OUT:
    s_waitcnt vmcnt(0)
    s_mov_b64 vcc, 0
    s_branch PO4_OK
    .fill 256, 4, 0xbf800000
.section .rodata,"a"
.p2align 6
.amdhsa_kernel standalone__w8a8_smoothquant_per_tensor_per_channel_int8_activations_weights__prompt_kernel
  .amdhsa_next_free_vgpr 384
  .amdhsa_next_free_sgpr 102
  .amdhsa_accum_offset 256
  .amdhsa_group_segment_fixed_size 0
  .amdhsa_kernarg_size 72
  .amdhsa_user_sgpr_count 2
  .amdhsa_user_sgpr_kernarg_segment_ptr 1
  .amdhsa_system_sgpr_workgroup_id_x 1
.end_amdhsa_kernel
```
